```python
import torch

def _softmax(x, axis=-1):
    return torch.softmax(x, dim=axis)

def _gelu(x):
    return torch.nn.functional.gelu(x, approximate='tanh')

def _silu(x):
    return torch.nn.functional.silu(x)

def _sigmoid(x):
    return torch.sigmoid(x)

def _layernorm(x, axis=-1, eps=1e-05):
    m = x.mean(dim=axis, keepdim=True)
    v = x.var(dim=axis, keepdim=True, unbiased=False)
    return (x - m) / torch.sqrt(v + eps)

def _scatter_add(tgt, idx, src, axis=0):
    return tgt.clone().index_add_(axis, idx, src)

def _segment_sum(src, seg, n):
    out = torch.zeros((n,) + src.shape[1:], dtype=src.dtype)
    return out.index_add_(0, seg, src)

def _pad(x, pw):
    flat = tuple((v for pair in reversed(pw) for v in pair))
    return torch.nn.functional.pad(x, flat)
kernel_name = 'recurrent_scan__sliding_local_dilated__mixer_gmlp__prompt'

def setup_inputs():

    _w = lambda a: (lambda t: t.to(torch.bfloat16) if t.is_floating_point() else t)(torch.as_tensor(a))

    def _A_setup():
        B, S, D = (1, 2048, 512)
        return {'x': _w((lambda *s: torch.randn(*s, dtype=torch.bfloat16) * 0.05)(B, S, D)), 'wqkv': _w((lambda *s: torch.randn(*s, dtype=torch.bfloat16) * 0.05)(D, 3 * D)), 'wo': _w((lambda *s: torch.randn(*s, dtype=torch.bfloat16) * 0.05)(D, D))}
    _A_in = _A_setup()

    def _B_setup():
        B, S, D, F = (1, 2048, 512, 1792)
        Fh = F // 2
        return {'x': _w((lambda *s: torch.randn(*s, dtype=torch.bfloat16) * 0.05)(B, S, D)), 'w_in': _w((lambda *s: torch.randn(*s, dtype=torch.bfloat16) * 0.4)(D, 2 * Fh)), 'w_sp': _w(0.01 * (lambda *s: torch.randn(*s, dtype=torch.bfloat16) * 0.4)(S, S)), 'b_sp': _w(1.0 + 0.01 * (lambda *s: torch.randn(*s, dtype=torch.bfloat16) * 0.05)(S)), 'w_out': _w((lambda *s: torch.randn(*s, dtype=torch.bfloat16) * 0.05)(Fh, D))}
    _B_in = _B_setup()
    return {'A_x': _A_in['x'], 'A_wqkv': _A_in['wqkv'], 'A_wo': _A_in['wo'], 'B_x': _B_in['x'], 'B_w_in': _B_in['w_in'], 'B_w_sp': _B_in['w_sp'], 'B_b_sp': _B_in['b_sp'], 'B_w_out': _B_in['w_out']}

def reference(A_x, A_wqkv, A_wo, B_x, B_w_in, B_w_sp, B_b_sp, B_w_out):

    def _A_ref(x, wqkv, wo):
        B, S, D = x.shape
        H = 32
        Dh = D // H
        W, dil = (8, 2)
        qkv = (lambda x, *d: x.permute(*d))((x @ wqkv).reshape(B, S, 3, H, Dh), 2, 0, 3, 1, 4)
        q, k, v = (qkv[0], qkv[1], qkv[2])
        scale = Dh ** (-0.5)
        pos = torch.arange(S)
        off = torch.arange(W) * dil
        idx = pos[:, None] - off[None, :]
        mask = idx >= 0
        idx_c = torch.where(mask, idx, 0).reshape(-1)
        kg = k[:, :, idx_c, :].reshape(B, H, S, W, Dh)
        vg = v[:, :, idx_c, :].reshape(B, H, S, W, Dh)
        logits = torch.einsum('bhsd,bhswd->bhsw', q, kg) * scale
        logits = torch.where(mask[None, None, :, :], logits, -1000000000.0)
        attn = _softmax(logits, axis=-1)
        o = torch.einsum('bhsw,bhswd->bhsd', attn, vg)
        return (lambda x, *d: x.permute(*d))(o, 0, 2, 1, 3).reshape(B, S, D) @ wo

    def _B_ref(x, w_in, w_sp, b_sp, w_out):
        B, S, D = x.shape
        F = w_in.shape[-1]
        Fh = F // 2
        z = _gelu(torch.einsum('bsd,df->bsf', x, w_in))
        z1 = z[..., :Fh].clone()
        z2 = _layernorm(z[..., Fh:], axis=-1)
        g = torch.einsum('ts,bsf->btf', w_sp, z2) + b_sp[None, :, None]
        return torch.einsum('bsf,fd->bsd', z1 * g, w_out)
    x = A_x
    xn = _layernorm(x, axis=-1)
    s = _A_ref(xn, A_wqkv, A_wo)
    g = _silu(_B_ref(xn, B_w_in, B_w_sp, B_b_sp, B_w_out))
    return x + s * g
```

```asm
; @launch grid=(256,1,1) block=(512,1,1) lds=163840
.amdgcn_target "amdgcn-amd-amdhsa--gfx950"
.text
.globl recurrent_scan__sliding_local_dilated__mixer_gmlp__prompt_kernel
.p2align 8
.type recurrent_scan__sliding_local_dilated__mixer_gmlp__prompt_kernel,@function
recurrent_scan__sliding_local_dilated__mixer_gmlp__prompt_kernel:
 s_memrealtime s[6:7]
 s_cmp_ge_u32 s2, 256
 s_cbranch_scc1 L_exit
 s_load_dwordx2 s[8:9], s[0:1], 0
 s_load_dwordx2 s[20:21], s[0:1], 32
 s_load_dwordx2 s[40:41], s[0:1], 72
 s_load_dwordx2 s[12:13], s[0:1], 8
 s_getpc_b64 s[4:5]
L_pc:
 s_lshr_b32 s62, s2, 3
 s_lshl_b32 s62, s62, 11
 v_lshl_add_u32 v15, v0, 2, s62
 v_min_u32 v15, L_end-L_pc-4, v15
 global_load_dword v13, v15, s[4:5]
 v_lshrrev_b32 v2, 6, v0
 v_and_b32 v1, 63, v0
 v_readfirstlane_b32 s50, v2
 s_and_b32 s60, s2, 7
 s_lshr_b32 s61, s2, 3
 s_lshr_b32 s48, s60, 2
 s_lshl_b32 s48, s48, 3
 s_lshr_b32 s62, s61, 2
 s_add_u32 s48, s48, s62
 s_lshl_b32 s48, s48, 1
 s_bfe_u32 s62, s60, 0x10001
 s_add_u32 s48, s48, s62
 s_and_b32 s49, s60, 1
 s_lshl_b32 s49, s49, 2
 s_add_u32 s62, s61, 0
 s_and_b32 s62, s62, 3
 s_add_u32 s49, s49, s62
 s_lshl_b32 s73, s48, 8
 s_and_b32 s73, s73, 512
 v_lshrrev_b32 v8, 3, v1
 v_and_b32 v9, 7, v1
 v_lshl_add_u32 v28, v8, 10, s73
 v_lshl_add_u32 v28, v9, 4, v28
 v_xor_b32 v29, 512, v28
 s_lshl_b32 s68, s49, 2
 s_and_b32 s68, s68, 4
 s_xor_b32 s68, s68, s50
 s_lshl_b32 s62, s48, 16
 s_lshl_b32 s63, s68, 13
 s_add_u32 s79, s62, s63
 s_mov_b32 s10, 2097152
 s_mov_b32 s11, 0x20000
 s_cmp_eq_u32 s49, 7
 s_cbranch_scc1 L_hpre
L_x0:
 s_cmp_ge_u32 s50, 4
 s_cbranch_scc1 L_x1
 s_waitcnt lgkmcnt(0)
 buffer_load_dwordx4 v[48:51], v28, s[8:11], s79 offen offset:0
 buffer_load_dwordx4 v[52:55], v28, s[8:11], s79 offen offset:128
 buffer_load_dwordx4 v[56:59], v28, s[8:11], s79 offen offset:256
 buffer_load_dwordx4 v[60:63], v28, s[8:11], s79 offen offset:384
 buffer_load_dwordx4 v[64:67], v29, s[8:11], s79 offen offset:0
 buffer_load_dwordx4 v[68:71], v29, s[8:11], s79 offen offset:128
 buffer_load_dwordx4 v[72:75], v29, s[8:11], s79 offen offset:256
 buffer_load_dwordx4 v[76:79], v29, s[8:11], s79 offen offset:384
L_x1:
 s_mov_b32 s22, 1835008
 s_mov_b32 s23, 0x20000
 s_mov_b32 s14, 1572864
 s_mov_b32 s15, 0x20000
 s_mov_b32 s18, 524288
 s_mov_b32 s19, 0x20000
 s_mov_b32 s26, 8388608
 s_mov_b32 s27, 0x20000
 s_mov_b32 s30, 4096
 s_mov_b32 s31, 0x20000
 s_mov_b32 s34, 917504
 s_mov_b32 s35, 0x20000
 s_mov_b32 s38, 2097152
 s_mov_b32 s39, 0x20000
 s_mov_b32 s42, 256
 s_mov_b32 s43, 0x20000
 s_mov_b32 s46, 268435456
 s_mov_b32 s47, 0x20000
 s_lshl_b32 s3, s48, 5
 s_and_b32 s3, s3, 128
 s_lshr_b32 s51, s50, 2
 s_and_b32 s52, s50, 3
 s_lshl_b32 s54, s50, 10
 v_lshlrev_b32 v2, 4, v1
 s_waitcnt lgkmcnt(0)
 s_load_dwordx2 s[16:17], s[0:1], 16
 s_load_dwordx2 s[24:25], s[0:1], 40
 s_load_dwordx2 s[28:29], s[0:1], 48
 s_load_dwordx2 s[32:33], s[0:1], 56
 s_load_dwordx2 s[36:37], s[0:1], 64
 s_load_dwordx2 s[44:45], s[0:1], 80
 s_or_b32 s62, s2, s50
 s_cmp_lg_u32 s62, 0
 s_cbranch_scc1 L_non_1
 v_mov_b32 v26, s6
 v_mov_b32 v27, 1
 s_mov_b64 exec, 1
 buffer_store_dwordx2 v[26:27], off, s[40:43], 0 sc1
 s_mov_b64 exec, -1
L_non_1:
 s_and_b32 s62, s50, 1
 s_lshl_b32 s63, s62, 2
 v_lshrrev_b32 v14, 4, v1
 v_lshlrev_b32 v16, 1, v14
 v_xor_b32 v16, s63, v16
 v_xor_b32 v16, v16, v9
 v_lshlrev_b32 v16, 4, v16
 v_mul_u32_u24 v3, 3584, v8
 v_add_u32 v3, v3, v16
 v_mul_u32_u24 v4, 3072, v8
 v_add_u32 v4, v4, v16
 v_lshl_add_u32 v6, v8, 10, v16
 v_add_u32 v14, s63, v14
 v_xor_b32 v14, v14, v9
 v_lshlrev_b32 v14, 4, v14
 v_lshl_add_u32 v5, v8, 13, v14
 s_mul_i32 s55, s50, 28672
 s_lshl_b32 s63, s49, 8
 s_add_u32 s55, s55, s63
 s_xor_b32 s61, s73, 512
 s_mul_i32 s63, s61, 1792
 s_add_u32 s56, s55, s63
 s_mul_i32 s63, s73, 1792
 s_add_u32 s55, s55, s63
 s_add_u32 s65, s49, 1
 s_xor_b32 s65, s65, s49
 s_and_b32 s65, s65, 4
 s_xor_b32 s65, s65, s49
 s_mul_i32 s57, s50, 24576
 s_lshl_b32 s63, s65, 7
 s_add_u32 s57, s57, s63
 s_mul_i32 s60, s73, 1536
 s_mul_i32 s61, s61, 1536
 s_add_u32 s73, s57, s61
 s_add_u32 s57, s57, s60
 s_lshl_b32 s59, s50, 13
 s_add_u32 s59, s59, s63
 s_lshl_b32 s69, s48, 6
 s_lshl_b32 s63, s51, 5
 s_add_u32 s69, s69, s63
 s_lshl_b32 s63, s62, 4
 s_add_u32 s69, s69, s63
 s_bfe_u32 s63, s50, 0x10001
 s_add_u32 s69, s69, s63
 s_lshl_b32 s69, s69, 12
 s_and_b32 s63, s48, 1
 s_lshl_b32 s63, s63, 11
 s_add_u32 s69, s69, s63
 s_lshl_b32 s63, s48, 9
 s_and_b32 s63, s63, 1024
 s_add_u32 s69, s69, s63
 s_xor_b32 s58, s69, 262144
 s_lshl_b32 s81, s48, 3
 s_add_u32 s81, s81, s49
 s_lshl_b32 s81, s81, 3
 s_add_u32 s81, s81, s50
 s_mov_b32 s66, 0x3f803f80
 s_mov_b32 s67, 0xffff0000
 s_lshl_b32 s62, s52, 2
 v_lshrrev_b32 v14, 4, v1
 v_add_u32 v14, s62, v14
 v_xor_b32 v14, v14, v9
 v_lshlrev_b32 v14, 4, v14
 v_lshl_add_u32 v14, v9, 8, v14
 v_and_b32 v15, 1, v8
 v_lshl_add_u32 v14, v15, 11, v14
 s_lshr_b32 s62, s68, 2
 s_lshl_b32 s62, s62, 12
 v_add_u32 v16, s62, v14
 s_lshl_b32 s62, s51, 12
 v_lshrrev_b32 v8, 4, v1
 v_and_b32 v9, 15, v1
 v_xor_b32 v14, v9, v8
 v_lshlrev_b32 v14, 4, v14
 v_lshl_add_u32 v14, v8, 8, v14
 v_add_u32 v14, s62, v14
 v_xor_b32 v15, 1088, v14
 v_mov_b32 v104, 0xffff0000
 v_lshrrev_b32 v108, 4, v1
 v_bfe_u32 v109, v1, 2, 2
 v_and_b32 v110, 3, v1
 v_lshl_add_u32 v111, v108, 3, v109
 v_lshlrev_b32 v111, 7, v111
 v_lshl_add_u32 v111, v110, 3, v111
 v_lshrrev_b32 v109, 1, v109
 v_and_b32 v110, 1, v108
 v_lshl_add_u32 v109, v110, 1, v109
 v_xor_b32 v109, s52, v109
 v_lshl_add_u32 v8, v109, 5, v111
 v_xor_b32 v9, 64, v8
 v_add_u32 v9, 512, v9
 v_mov_b32 v96, 0
 v_mov_b32 v97, 0
 v_mov_b32 v98, 0
 v_mov_b32 v99, 0
 s_cmp_eq_u32 s51, 0
 s_cbranch_scc1 L_x2
 buffer_load_dwordx4 v[48:51], v28, s[8:11], s79 offen offset:0
 buffer_load_dwordx4 v[52:55], v28, s[8:11], s79 offen offset:128
 buffer_load_dwordx4 v[56:59], v28, s[8:11], s79 offen offset:256
 buffer_load_dwordx4 v[60:63], v28, s[8:11], s79 offen offset:384
 buffer_load_dwordx4 v[64:67], v29, s[8:11], s79 offen offset:0
 buffer_load_dwordx4 v[68:71], v29, s[8:11], s79 offen offset:128
 buffer_load_dwordx4 v[72:75], v29, s[8:11], s79 offen offset:256
 buffer_load_dwordx4 v[76:79], v29, s[8:11], s79 offen offset:384
L_x2:
 s_waitcnt lgkmcnt(0)
 s_cmp_eq_u32 s49, 7
 s_cbranch_scc1 L_progh
 s_waitcnt vmcnt(7)
 v_dot2c_f32_bf16 v96, s66, v48
 v_lshlrev_b32 v128, 16, v48
 v_dot2c_f32_bf16 v97, v48, v48
 v_and_b32 v129, v104, v48
 v_dot2c_f32_bf16 v98, s66, v49
 v_lshlrev_b32 v130, 16, v49
 v_dot2c_f32_bf16 v99, v49, v49
 v_and_b32 v131, v104, v49
 v_dot2c_f32_bf16 v96, s66, v50
 v_lshlrev_b32 v132, 16, v50
 v_dot2c_f32_bf16 v97, v50, v50
 v_and_b32 v133, v104, v50
 v_dot2c_f32_bf16 v98, s66, v51
 v_lshlrev_b32 v134, 16, v51
 v_dot2c_f32_bf16 v99, v51, v51
 v_and_b32 v135, v104, v51
 s_waitcnt vmcnt(6)
 v_dot2c_f32_bf16 v96, s66, v52
 v_lshlrev_b32 v136, 16, v52
 v_dot2c_f32_bf16 v97, v52, v52
 v_and_b32 v137, v104, v52
 v_dot2c_f32_bf16 v98, s66, v53
 v_lshlrev_b32 v138, 16, v53
 v_dot2c_f32_bf16 v99, v53, v53
 v_and_b32 v139, v104, v53
 v_dot2c_f32_bf16 v96, s66, v54
 v_lshlrev_b32 v140, 16, v54
 v_dot2c_f32_bf16 v97, v54, v54
 v_and_b32 v141, v104, v54
 v_dot2c_f32_bf16 v98, s66, v55
 v_lshlrev_b32 v142, 16, v55
 v_dot2c_f32_bf16 v99, v55, v55
 v_and_b32 v143, v104, v55
 s_waitcnt vmcnt(5)
 v_dot2c_f32_bf16 v96, s66, v56
 v_lshlrev_b32 v144, 16, v56
 v_dot2c_f32_bf16 v97, v56, v56
 v_and_b32 v145, v104, v56
 v_dot2c_f32_bf16 v98, s66, v57
 v_lshlrev_b32 v146, 16, v57
 v_dot2c_f32_bf16 v99, v57, v57
 v_and_b32 v147, v104, v57
 v_dot2c_f32_bf16 v96, s66, v58
 v_lshlrev_b32 v148, 16, v58
 v_dot2c_f32_bf16 v97, v58, v58
 v_and_b32 v149, v104, v58
 v_dot2c_f32_bf16 v98, s66, v59
 v_lshlrev_b32 v150, 16, v59
 v_dot2c_f32_bf16 v99, v59, v59
 v_and_b32 v151, v104, v59
 s_waitcnt vmcnt(4)
 v_dot2c_f32_bf16 v96, s66, v60
 v_lshlrev_b32 v152, 16, v60
 v_dot2c_f32_bf16 v97, v60, v60
 v_and_b32 v153, v104, v60
 v_dot2c_f32_bf16 v98, s66, v61
 v_lshlrev_b32 v154, 16, v61
 v_dot2c_f32_bf16 v99, v61, v61
 v_and_b32 v155, v104, v61
 v_dot2c_f32_bf16 v96, s66, v62
 v_lshlrev_b32 v156, 16, v62
 v_dot2c_f32_bf16 v97, v62, v62
 v_and_b32 v157, v104, v62
 v_dot2c_f32_bf16 v98, s66, v63
 v_lshlrev_b32 v158, 16, v63
 v_dot2c_f32_bf16 v99, v63, v63
 v_and_b32 v159, v104, v63
 s_waitcnt vmcnt(3)
 v_dot2c_f32_bf16 v96, s66, v64
 v_lshlrev_b32 v160, 16, v64
 v_dot2c_f32_bf16 v97, v64, v64
 v_and_b32 v161, v104, v64
 v_dot2c_f32_bf16 v98, s66, v65
 v_lshlrev_b32 v162, 16, v65
 v_dot2c_f32_bf16 v99, v65, v65
 v_and_b32 v163, v104, v65
 v_dot2c_f32_bf16 v96, s66, v66
 v_lshlrev_b32 v164, 16, v66
 v_dot2c_f32_bf16 v97, v66, v66
 v_and_b32 v165, v104, v66
 v_dot2c_f32_bf16 v98, s66, v67
 v_lshlrev_b32 v166, 16, v67
 v_dot2c_f32_bf16 v99, v67, v67
 v_and_b32 v167, v104, v67
 s_waitcnt vmcnt(2)
 v_dot2c_f32_bf16 v96, s66, v68
 v_lshlrev_b32 v168, 16, v68
 v_dot2c_f32_bf16 v97, v68, v68
 v_and_b32 v169, v104, v68
 v_dot2c_f32_bf16 v98, s66, v69
 v_lshlrev_b32 v170, 16, v69
 v_dot2c_f32_bf16 v99, v69, v69
 v_and_b32 v171, v104, v69
 v_dot2c_f32_bf16 v96, s66, v70
 v_lshlrev_b32 v172, 16, v70
 v_dot2c_f32_bf16 v97, v70, v70
 v_and_b32 v173, v104, v70
 v_dot2c_f32_bf16 v98, s66, v71
 v_lshlrev_b32 v174, 16, v71
 v_dot2c_f32_bf16 v99, v71, v71
 v_and_b32 v175, v104, v71
 s_waitcnt vmcnt(1)
 v_dot2c_f32_bf16 v96, s66, v72
 v_lshlrev_b32 v176, 16, v72
 v_dot2c_f32_bf16 v97, v72, v72
 v_and_b32 v177, v104, v72
 v_dot2c_f32_bf16 v98, s66, v73
 v_lshlrev_b32 v178, 16, v73
 v_dot2c_f32_bf16 v99, v73, v73
 v_and_b32 v179, v104, v73
 v_dot2c_f32_bf16 v96, s66, v74
 v_lshlrev_b32 v180, 16, v74
 v_dot2c_f32_bf16 v97, v74, v74
 v_and_b32 v181, v104, v74
 v_dot2c_f32_bf16 v98, s66, v75
 v_lshlrev_b32 v182, 16, v75
 v_dot2c_f32_bf16 v99, v75, v75
 v_and_b32 v183, v104, v75
 s_waitcnt vmcnt(0)
 v_dot2c_f32_bf16 v96, s66, v76
 v_lshlrev_b32 v184, 16, v76
 v_dot2c_f32_bf16 v97, v76, v76
 v_and_b32 v185, v104, v76
 v_dot2c_f32_bf16 v98, s66, v77
 v_lshlrev_b32 v186, 16, v77
 v_dot2c_f32_bf16 v99, v77, v77
 v_and_b32 v187, v104, v77
 v_dot2c_f32_bf16 v96, s66, v78
 v_lshlrev_b32 v188, 16, v78
 v_dot2c_f32_bf16 v97, v78, v78
 v_and_b32 v189, v104, v78
 v_dot2c_f32_bf16 v98, s66, v79
 v_lshlrev_b32 v190, 16, v79
 v_dot2c_f32_bf16 v99, v79, v79
 v_and_b32 v191, v104, v79
 s_xor_b32 s71, s3, 0
 s_add_u32 s71, s71, s55
 s_add_u32 m0, s54, 65536
 s_add_u32 s60, s71, 1792
 buffer_load_dwordx4 v3, s[20:23], s60 offen lds
 s_add_u32 m0, s54, 73728
 s_add_u32 s60, s71, 231168
 buffer_load_dwordx4 v3, s[20:23], s60 offen lds
 s_add_u32 m0, s54, 81920
 s_add_u32 s60, s71, 460544
 buffer_load_dwordx4 v3, s[20:23], s60 offen lds
 s_add_u32 m0, s54, 90112
 s_add_u32 s60, s71, 689920
 buffer_load_dwordx4 v3, s[20:23], s60 offen lds
 v_pk_add_f32 v[96:97], v[96:97], v[98:99]
 s_nop 1
 v_add_f32_dpp v96, v96, v96 quad_perm:[1,0,3,2] row_mask:0xf bank_mask:0xf
 v_add_f32_dpp v97, v97, v97 quad_perm:[1,0,3,2] row_mask:0xf bank_mask:0xf
 s_nop 0
 v_add_f32_dpp v96, v96, v96 quad_perm:[2,3,0,1] row_mask:0xf bank_mask:0xf
 v_add_f32_dpp v97, v97, v97 quad_perm:[2,3,0,1] row_mask:0xf bank_mask:0xf
 s_nop 0
 v_add_f32_dpp v96, v96, v96 row_half_mirror row_mask:0xf bank_mask:0xf
 v_add_f32_dpp v97, v97, v97 row_half_mirror row_mask:0xf bank_mask:0xf
 v_mul_f32 v96, 0xbb000000, v96
 v_mul_f32 v97, 0x3b000000, v97
 v_fma_f32 v97, -v96, v96, v97
 v_max_f32 v97, 0, v97
 v_add_f32 v97, 0x3727c5ac, v97
 v_rsq_f32 v100, v97
 s_nop 0
 v_mul_f32 v102, v96, v100
 v_mov_b32 v101, v100
 v_mov_b32 v103, v102
 v_pk_fma_f32 v[128:129], v[128:129], v[100:101], v[102:103]
 v_pk_fma_f32 v[130:131], v[130:131], v[100:101], v[102:103]
 v_pk_fma_f32 v[132:133], v[132:133], v[100:101], v[102:103]
 v_pk_fma_f32 v[134:135], v[134:135], v[100:101], v[102:103]
 v_cvt_pk_bf16_f32 v48, v128, v129
 v_cvt_pk_bf16_f32 v49, v130, v131
 v_cvt_pk_bf16_f32 v50, v132, v133
 v_cvt_pk_bf16_f32 v51, v134, v135
 ds_write_b128 v16, v[48:51] offset:0
 v_pk_fma_f32 v[136:137], v[136:137], v[100:101], v[102:103]
 v_pk_fma_f32 v[138:139], v[138:139], v[100:101], v[102:103]
 v_pk_fma_f32 v[140:141], v[140:141], v[100:101], v[102:103]
 v_pk_fma_f32 v[142:143], v[142:143], v[100:101], v[102:103]
 v_cvt_pk_bf16_f32 v52, v136, v137
 v_cvt_pk_bf16_f32 v53, v138, v139
 v_cvt_pk_bf16_f32 v54, v140, v141
 v_cvt_pk_bf16_f32 v55, v142, v143
 ds_write_b128 v16, v[52:55] offset:8192
 v_pk_fma_f32 v[144:145], v[144:145], v[100:101], v[102:103]
 v_pk_fma_f32 v[146:147], v[146:147], v[100:101], v[102:103]
 v_pk_fma_f32 v[148:149], v[148:149], v[100:101], v[102:103]
 v_pk_fma_f32 v[150:151], v[150:151], v[100:101], v[102:103]
 v_cvt_pk_bf16_f32 v56, v144, v145
 v_cvt_pk_bf16_f32 v57, v146, v147
 v_cvt_pk_bf16_f32 v58, v148, v149
 v_cvt_pk_bf16_f32 v59, v150, v151
 ds_write_b128 v16, v[56:59] offset:16384
 v_pk_fma_f32 v[152:153], v[152:153], v[100:101], v[102:103]
 v_pk_fma_f32 v[154:155], v[154:155], v[100:101], v[102:103]
 v_pk_fma_f32 v[156:157], v[156:157], v[100:101], v[102:103]
 v_pk_fma_f32 v[158:159], v[158:159], v[100:101], v[102:103]
 v_cvt_pk_bf16_f32 v60, v152, v153
 v_cvt_pk_bf16_f32 v61, v154, v155
 v_cvt_pk_bf16_f32 v62, v156, v157
 v_cvt_pk_bf16_f32 v63, v158, v159
 ds_write_b128 v16, v[60:63] offset:24576
 v_pk_fma_f32 v[160:161], v[160:161], v[100:101], v[102:103]
 v_pk_fma_f32 v[162:163], v[162:163], v[100:101], v[102:103]
 v_pk_fma_f32 v[164:165], v[164:165], v[100:101], v[102:103]
 v_pk_fma_f32 v[166:167], v[166:167], v[100:101], v[102:103]
 v_cvt_pk_bf16_f32 v64, v160, v161
 v_cvt_pk_bf16_f32 v65, v162, v163
 v_cvt_pk_bf16_f32 v66, v164, v165
 v_cvt_pk_bf16_f32 v67, v166, v167
 ds_write_b128 v16, v[64:67] offset:32768
 v_pk_fma_f32 v[168:169], v[168:169], v[100:101], v[102:103]
 v_pk_fma_f32 v[170:171], v[170:171], v[100:101], v[102:103]
 v_pk_fma_f32 v[172:173], v[172:173], v[100:101], v[102:103]
 v_pk_fma_f32 v[174:175], v[174:175], v[100:101], v[102:103]
 v_cvt_pk_bf16_f32 v68, v168, v169
 v_cvt_pk_bf16_f32 v69, v170, v171
 v_cvt_pk_bf16_f32 v70, v172, v173
 v_cvt_pk_bf16_f32 v71, v174, v175
 ds_write_b128 v16, v[68:71] offset:40960
 v_pk_fma_f32 v[176:177], v[176:177], v[100:101], v[102:103]
 v_pk_fma_f32 v[178:179], v[178:179], v[100:101], v[102:103]
 v_pk_fma_f32 v[180:181], v[180:181], v[100:101], v[102:103]
 v_pk_fma_f32 v[182:183], v[182:183], v[100:101], v[102:103]
 v_cvt_pk_bf16_f32 v72, v176, v177
 v_cvt_pk_bf16_f32 v73, v178, v179
 v_cvt_pk_bf16_f32 v74, v180, v181
 v_cvt_pk_bf16_f32 v75, v182, v183
 ds_write_b128 v16, v[72:75] offset:49152
 v_pk_fma_f32 v[184:185], v[184:185], v[100:101], v[102:103]
 v_pk_fma_f32 v[186:187], v[186:187], v[100:101], v[102:103]
 v_pk_fma_f32 v[188:189], v[188:189], v[100:101], v[102:103]
 v_pk_fma_f32 v[190:191], v[190:191], v[100:101], v[102:103]
 v_cvt_pk_bf16_f32 v76, v184, v185
 v_cvt_pk_bf16_f32 v77, v186, v187
 v_cvt_pk_bf16_f32 v78, v188, v189
 v_cvt_pk_bf16_f32 v79, v190, v191
 ds_write_b128 v16, v[76:79] offset:57344
 s_cmp_lg_u32 s51, 0
 s_cbranch_scc1 L_o_2
L_o_2:
 s_waitcnt vmcnt(0)
 s_waitcnt lgkmcnt(0)
 s_barrier
 s_xor_b32 s71, s3, 0
 s_add_u32 s71, s71, s56
 s_add_u32 m0, s54, 98304
 s_add_u32 s60, s71, 1792
 buffer_load_dwordx4 v3, s[20:23], s60 offen lds
 s_add_u32 m0, s54, 106496
 s_add_u32 s60, s71, 231168
 buffer_load_dwordx4 v3, s[20:23], s60 offen lds
 s_add_u32 m0, s54, 114688
 s_add_u32 s60, s71, 460544
 buffer_load_dwordx4 v3, s[20:23], s60 offen lds
 s_add_u32 m0, s54, 122880
 s_add_u32 s60, s71, 689920
 buffer_load_dwordx4 v3, s[20:23], s60 offen lds
 v_add_u32 v8, 0x10000, v8
 v_add_u32 v9, 0x10000, v9
 ds_read_b64_tr_b16 v[48:49], v8 offset:0
 ds_read_b64_tr_b16 v[50:51], v9 offset:0
 ds_read_b128 v[128:131], v14 offset:0
 ds_read_b128 v[192:195], v14 offset:2048
 ds_read_b64_tr_b16 v[52:53], v8 offset:4096
 ds_read_b64_tr_b16 v[54:55], v9 offset:4096
 ds_read_b128 v[132:135], v15 offset:0
 ds_read_b128 v[196:199], v15 offset:2048
 ds_read_b64_tr_b16 v[56:57], v8 offset:8192
 ds_read_b64_tr_b16 v[58:59], v9 offset:8192
 ds_read_b128 v[136:139], v14 offset:8192
 ds_read_b128 v[200:203], v14 offset:10240
 ds_read_b64_tr_b16 v[60:61], v8 offset:12288
 ds_read_b64_tr_b16 v[62:63], v9 offset:12288
 ds_read_b128 v[140:143], v15 offset:8192
 ds_read_b128 v[204:207], v15 offset:10240
 s_waitcnt lgkmcnt(12)
 v_mfma_f32_16x16x32_bf16 v[16:19], v[48:51], v[128:131], 0
 ds_read_b64_tr_b16 v[64:65], v8 offset:16384
 ds_read_b64_tr_b16 v[66:67], v9 offset:16384
 v_mfma_f32_16x16x32_bf16 v[24:27], v[48:51], v[192:195], 0
 ds_read_b128 v[144:147], v14 offset:16384
 ds_read_b128 v[208:211], v14 offset:18432
 s_xor_b32 s71, s3, 128
 s_add_u32 s71, s71, s55
 s_add_u32 m0, s54, 131072
 s_add_u32 s60, s71, 1792
 buffer_load_dwordx4 v3, s[20:23], s60 offen lds
 s_waitcnt lgkmcnt(12)
 v_mfma_f32_16x16x32_bf16 v[16:19], v[52:55], v[132:135], v[16:19]
 ds_read_b64_tr_b16 v[68:69], v8 offset:20480
 ds_read_b64_tr_b16 v[70:71], v9 offset:20480
 v_mfma_f32_16x16x32_bf16 v[24:27], v[52:55], v[196:199], v[24:27]
 ds_read_b128 v[148:151], v15 offset:16384
 ds_read_b128 v[212:215], v15 offset:18432
 s_add_u32 m0, s54, 139264
 s_add_u32 s60, s71, 231168
 buffer_load_dwordx4 v3, s[20:23], s60 offen lds
 s_waitcnt lgkmcnt(12)
 v_mfma_f32_16x16x32_bf16 v[16:19], v[56:59], v[136:139], v[16:19]
 ds_read_b64_tr_b16 v[72:73], v8 offset:24576
 ds_read_b64_tr_b16 v[74:75], v9 offset:24576
 v_mfma_f32_16x16x32_bf16 v[24:27], v[56:59], v[200:203], v[24:27]
 ds_read_b128 v[152:155], v14 offset:24576
 ds_read_b128 v[216:219], v14 offset:26624
 s_add_u32 m0, s54, 147456
 s_add_u32 s60, s71, 460544
 buffer_load_dwordx4 v3, s[20:23], s60 offen lds
 s_waitcnt lgkmcnt(12)
 v_mfma_f32_16x16x32_bf16 v[16:19], v[60:63], v[140:143], v[16:19]
 ds_read_b64_tr_b16 v[76:77], v8 offset:28672
 ds_read_b64_tr_b16 v[78:79], v9 offset:28672
 v_mfma_f32_16x16x32_bf16 v[24:27], v[60:63], v[204:207], v[24:27]
 ds_read_b128 v[156:159], v15 offset:24576
 ds_read_b128 v[220:223], v15 offset:26624
 s_add_u32 m0, s54, 155648
 s_add_u32 s60, s71, 689920
 buffer_load_dwordx4 v3, s[20:23], s60 offen lds
 s_waitcnt vmcnt(4)
 s_waitcnt lgkmcnt(0)
 s_barrier
 v_mfma_f32_16x16x32_bf16 v[16:19], v[64:67], v[144:147], v[16:19]
 ds_read_b64_tr_b16 v[48:49], v8 offset:32768
 ds_read_b64_tr_b16 v[50:51], v9 offset:32768
 v_mfma_f32_16x16x32_bf16 v[24:27], v[64:67], v[208:211], v[24:27]
 ds_read_b128 v[160:163], v14 offset:32768
 ds_read_b128 v[224:227], v14 offset:34816
 s_xor_b32 s71, s3, 128
 s_add_u32 s71, s71, s56
 s_add_u32 m0, s54, 65536
 s_add_u32 s60, s71, 1792
 buffer_load_dwordx4 v3, s[20:23], s60 offen lds
 v_mfma_f32_16x16x32_bf16 v[16:19], v[68:71], v[148:151], v[16:19]
 ds_read_b64_tr_b16 v[52:53], v8 offset:36864
 ds_read_b64_tr_b16 v[54:55], v9 offset:36864
 v_mfma_f32_16x16x32_bf16 v[24:27], v[68:71], v[212:215], v[24:27]
 ds_read_b128 v[164:167], v15 offset:32768
 ds_read_b128 v[228:231], v15 offset:34816
 s_add_u32 m0, s54, 73728
 s_add_u32 s60, s71, 231168
 buffer_load_dwordx4 v3, s[20:23], s60 offen lds
 v_mfma_f32_16x16x32_bf16 v[16:19], v[72:75], v[152:155], v[16:19]
 ds_read_b64_tr_b16 v[56:57], v8 offset:40960
 ds_read_b64_tr_b16 v[58:59], v9 offset:40960
 v_mfma_f32_16x16x32_bf16 v[24:27], v[72:75], v[216:219], v[24:27]
 ds_read_b128 v[168:171], v14 offset:40960
 ds_read_b128 v[232:235], v14 offset:43008
 s_add_u32 m0, s54, 81920
 s_add_u32 s60, s71, 460544
 buffer_load_dwordx4 v3, s[20:23], s60 offen lds
 v_mfma_f32_16x16x32_bf16 v[16:19], v[76:79], v[156:159], v[16:19]
 ds_read_b64_tr_b16 v[60:61], v8 offset:45056
 ds_read_b64_tr_b16 v[62:63], v9 offset:45056
 v_mfma_f32_16x16x32_bf16 v[24:27], v[76:79], v[220:223], v[24:27]
 ds_read_b128 v[172:175], v15 offset:40960
 ds_read_b128 v[236:239], v15 offset:43008
 v_and_b32 v10, 15, v1
 v_lshlrev_b32 v10, 2, v10
 s_lshl_b32 s62, s48, 7
 s_lshl_b32 s63, s51, 6
 s_add_u32 s62, s62, s63
 buffer_load_dword v7, v10, s[28:31], s62 offen
 buffer_load_dwordx2 v[12:13], off, s[40:43], 0 sc1
 s_waitcnt lgkmcnt(12)
 v_mfma_f32_16x16x32_bf16 v[16:19], v[48:51], v[160:163], v[16:19]
 ds_read_b64_tr_b16 v[64:65], v8 offset:49152
 ds_read_b64_tr_b16 v[66:67], v9 offset:49152
 v_mfma_f32_16x16x32_bf16 v[24:27], v[48:51], v[224:227], v[24:27]
 ds_read_b128 v[176:179], v14 offset:49152
 ds_read_b128 v[240:243], v14 offset:51200
 s_add_u32 m0, s54, 90112
 s_add_u32 s60, s71, 689920
 buffer_load_dwordx4 v3, s[20:23], s60 offen lds
 s_waitcnt lgkmcnt(12)
 v_mfma_f32_16x16x32_bf16 v[16:19], v[52:55], v[164:167], v[16:19]
 ds_read_b64_tr_b16 v[68:69], v8 offset:53248
 ds_read_b64_tr_b16 v[70:71], v9 offset:53248
 v_mfma_f32_16x16x32_bf16 v[24:27], v[52:55], v[228:231], v[24:27]
 ds_read_b128 v[180:183], v15 offset:49152
 ds_read_b128 v[244:247], v15 offset:51200
 s_add_u32 m0, s54, 0
 s_add_u32 s60, s57, 1024
 buffer_load_dwordx4 v4, s[12:15], s60 offen lds
 s_waitcnt lgkmcnt(12)
 v_mfma_f32_16x16x32_bf16 v[16:19], v[56:59], v[168:171], v[16:19]
 ds_read_b64_tr_b16 v[72:73], v8 offset:57344
 ds_read_b64_tr_b16 v[74:75], v9 offset:57344
 v_mfma_f32_16x16x32_bf16 v[24:27], v[56:59], v[232:235], v[24:27]
 ds_read_b128 v[184:187], v14 offset:57344
 ds_read_b128 v[248:251], v14 offset:59392
 s_add_u32 m0, s54, 8192
 s_add_u32 s60, s57, 197632
 buffer_load_dwordx4 v4, s[12:15], s60 offen lds
 s_waitcnt lgkmcnt(12)
 v_mfma_f32_16x16x32_bf16 v[16:19], v[60:63], v[172:175], v[16:19]
 ds_read_b64_tr_b16 v[76:77], v8 offset:61440
 ds_read_b64_tr_b16 v[78:79], v9 offset:61440
 v_mfma_f32_16x16x32_bf16 v[24:27], v[60:63], v[236:239], v[24:27]
 ds_read_b128 v[188:191], v15 offset:57344
 ds_read_b128 v[252:255], v15 offset:59392
 s_waitcnt vmcnt(8)
 s_waitcnt lgkmcnt(0)
 s_barrier
 v_add_u32 v8, 0x10000, v8
 v_add_u32 v9, 0x10000, v9
 v_mfma_f32_16x16x32_bf16 v[16:19], v[64:67], v[176:179], v[16:19]
 ds_read_b64_tr_b16 v[48:49], v8 offset:0
 v_mfma_f32_16x16x32_bf16 v[24:27], v[64:67], v[240:243], v[24:27]
 ds_read_b64_tr_b16 v[50:51], v9 offset:0
 s_add_u32 m0, s54, 16384
 s_add_u32 s60, s57, 394240
 buffer_load_dwordx4 v4, s[12:15], s60 offen lds
 v_mfma_f32_16x16x32_bf16 v[16:19], v[68:71], v[180:183], v[16:19]
 ds_read_b64_tr_b16 v[52:53], v8 offset:4096
 v_mfma_f32_16x16x32_bf16 v[24:27], v[68:71], v[244:247], v[24:27]
 ds_read_b64_tr_b16 v[54:55], v9 offset:4096
 s_add_u32 m0, s54, 24576
 s_add_u32 s60, s57, 590848
 buffer_load_dwordx4 v4, s[12:15], s60 offen lds
 v_mfma_f32_16x16x32_bf16 v[16:19], v[72:75], v[184:187], v[16:19]
 ds_read_b64_tr_b16 v[56:57], v8 offset:8192
 v_mfma_f32_16x16x32_bf16 v[24:27], v[72:75], v[248:251], v[24:27]
 ds_read_b64_tr_b16 v[58:59], v9 offset:8192
 s_add_u32 m0, s54, 32768
 s_add_u32 s60, s73, 1024
 buffer_load_dwordx4 v4, s[12:15], s60 offen lds
 v_mfma_f32_16x16x32_bf16 v[16:19], v[76:79], v[188:191], v[16:19]
 ds_read_b64_tr_b16 v[60:61], v8 offset:12288
 v_mfma_f32_16x16x32_bf16 v[24:27], v[76:79], v[252:255], v[24:27]
 ds_read_b64_tr_b16 v[62:63], v9 offset:12288
 s_waitcnt lgkmcnt(6)
 v_mfma_f32_16x16x32_bf16 v[20:23], v[48:51], v[128:131], 0
 ds_read_b64_tr_b16 v[64:65], v8 offset:16384
 v_mov_b32 v15, 0xc0135761
 s_nop 0
 v_mul_f32 v40, v16, v16
 v_mul_f32 v41, v17, v17
 v_mul_f32 v42, v18, v18
 v_mfma_f32_16x16x32_bf16 v[28:31], v[48:51], v[192:195], 0
 ds_read_b64_tr_b16 v[66:67], v9 offset:16384
 s_add_u32 m0, s54, 40960
 s_add_u32 s60, s73, 197632
 buffer_load_dwordx4 v4, s[12:15], s60 offen lds
 v_mul_f32 v43, v19, v19
 v_mul_f32 v44, v24, v24
 v_mul_f32 v45, v25, v25
 s_waitcnt lgkmcnt(6)
 v_mfma_f32_16x16x32_bf16 v[20:23], v[52:55], v[132:135], v[20:23]
 ds_read_b64_tr_b16 v[68:69], v8 offset:20480
 v_mul_f32 v46, v26, v26
 v_mul_f32 v47, v27, v27
 v_fmamk_f32 v40, v40, 0xbdd2d3e8, v15
 v_mfma_f32_16x16x32_bf16 v[28:31], v[52:55], v[196:199], v[28:31]
 ds_read_b64_tr_b16 v[70:71], v9 offset:20480
 s_add_u32 m0, s54, 49152
 s_add_u32 s60, s73, 394240
 buffer_load_dwordx4 v4, s[12:15], s60 offen lds
 v_fmamk_f32 v41, v41, 0xbdd2d3e8, v15
 v_fmamk_f32 v42, v42, 0xbdd2d3e8, v15
 v_fmamk_f32 v43, v43, 0xbdd2d3e8, v15
 s_waitcnt lgkmcnt(6)
 v_mfma_f32_16x16x32_bf16 v[20:23], v[56:59], v[136:139], v[20:23]
 ds_read_b64_tr_b16 v[72:73], v8 offset:24576
 v_fmamk_f32 v44, v44, 0xbdd2d3e8, v15
 v_fmamk_f32 v45, v45, 0xbdd2d3e8, v15
 v_fmamk_f32 v46, v46, 0xbdd2d3e8, v15
 v_mfma_f32_16x16x32_bf16 v[28:31], v[56:59], v[200:203], v[28:31]
 ds_read_b64_tr_b16 v[74:75], v9 offset:24576
 s_add_u32 m0, s54, 57344
 s_add_u32 s60, s73, 590848
 buffer_load_dwordx4 v4, s[12:15], s60 offen lds
 v_fmamk_f32 v47, v47, 0xbdd2d3e8, v15
 v_mul_f32 v40, v40, v16
 v_mul_f32 v41, v41, v17
 s_waitcnt lgkmcnt(6)
 v_mfma_f32_16x16x32_bf16 v[20:23], v[60:63], v[140:143], v[20:23]
 ds_read_b64_tr_b16 v[76:77], v8 offset:28672
 v_mul_f32 v42, v42, v18
 v_mul_f32 v43, v43, v19
 v_mul_f32 v44, v44, v24
 v_mfma_f32_16x16x32_bf16 v[28:31], v[60:63], v[204:207], v[28:31]
 ds_read_b64_tr_b16 v[78:79], v9 offset:28672
 v_mul_f32 v45, v45, v25
 v_mul_f32 v46, v46, v26
 v_mul_f32 v47, v47, v27
 s_waitcnt vmcnt(8)
 s_waitcnt lgkmcnt(0)
 s_barrier
 v_add_u32 v8, 0xffff0000, v8
 v_add_u32 v9, 0xffff0000, v9
 v_mfma_f32_16x16x32_bf16 v[20:23], v[64:67], v[144:147], v[20:23]
 ds_read_b64_tr_b16 v[48:49], v8 offset:0
 v_exp_f32 v40, v40
 v_exp_f32 v41, v41
 v_mfma_f32_16x16x32_bf16 v[28:31], v[64:67], v[208:211], v[28:31]
 ds_read_b64_tr_b16 v[50:51], v9 offset:0
 v_exp_f32 v42, v42
 v_mfma_f32_16x16x32_bf16 v[20:23], v[68:71], v[148:151], v[20:23]
 ds_read_b64_tr_b16 v[52:53], v8 offset:4096
 v_exp_f32 v43, v43
 v_exp_f32 v44, v44
 v_mfma_f32_16x16x32_bf16 v[28:31], v[68:71], v[212:215], v[28:31]
 ds_read_b64_tr_b16 v[54:55], v9 offset:4096
 s_add_u32 m0, s54, 98304
 s_add_u32 s60, s57, 2048
 buffer_load_dwordx4 v4, s[12:15], s60 offen lds
 v_exp_f32 v45, v45
 v_mfma_f32_16x16x32_bf16 v[20:23], v[72:75], v[152:155], v[20:23]
 ds_read_b64_tr_b16 v[56:57], v8 offset:8192
 v_exp_f32 v46, v46
 v_exp_f32 v47, v47
 v_mfma_f32_16x16x32_bf16 v[28:31], v[72:75], v[216:219], v[28:31]
 ds_read_b64_tr_b16 v[58:59], v9 offset:8192
 v_add_f32 v40, 1.0, v40
 v_add_f32 v41, 1.0, v41
 v_mfma_f32_16x16x32_bf16 v[20:23], v[76:79], v[156:159], v[20:23]
 ds_read_b64_tr_b16 v[60:61], v8 offset:12288
 v_add_f32 v42, 1.0, v42
 v_add_f32 v43, 1.0, v43
 v_add_f32 v44, 1.0, v44
 v_mfma_f32_16x16x32_bf16 v[28:31], v[76:79], v[220:223], v[28:31]
 ds_read_b64_tr_b16 v[62:63], v9 offset:12288
 s_add_u32 m0, s54, 106496
 s_add_u32 s60, s57, 198656
 buffer_load_dwordx4 v4, s[12:15], s60 offen lds
 v_add_f32 v45, 1.0, v45
 v_add_f32 v46, 1.0, v46
 v_add_f32 v47, 1.0, v47
 v_cmp_eq_u32 vcc, 0, v13
 s_cbranch_vccz L_ok_3
 s_mov_b32 s70, 50000
L_spin_4:
 s_sleep 1
 buffer_load_dwordx2 v[12:13], off, s[40:43], 0 sc1
 s_waitcnt vmcnt(0)
 s_sub_u32 s70, s70, 1
 s_cbranch_scc1 L_ok_3
 v_cmp_eq_u32 vcc, 0, v13
 s_cbranch_vccnz L_spin_4
L_ok_3:
 v_readfirstlane_b32 s53, v12
 v_mov_b32 v0, v12
 s_lshl_b32 s62, s51, 10
 s_add_u32 s62, s62, 151552
 v_lshl_add_u32 v11, v1, 2, s62
 s_lshl_b32 s62, s52, 8
 v_add_u32 v10, s62, v11
 s_waitcnt lgkmcnt(6)
 v_mfma_f32_16x16x32_bf16 v[20:23], v[48:51], v[160:163], v[20:23]
 ds_read_b64_tr_b16 v[64:65], v8 offset:16384
 v_rcp_f32 v40, v40
 v_rcp_f32 v41, v41
 v_mfma_f32_16x16x32_bf16 v[28:31], v[48:51], v[224:227], v[28:31]
 ds_read_b64_tr_b16 v[66:67], v9 offset:16384
 v_rcp_f32 v42, v42
 s_waitcnt lgkmcnt(6)
 v_mfma_f32_16x16x32_bf16 v[20:23], v[52:55], v[164:167], v[20:23]
 ds_read_b64_tr_b16 v[68:69], v8 offset:20480
 v_rcp_f32 v43, v43
 v_rcp_f32 v44, v44
 v_mfma_f32_16x16x32_bf16 v[28:31], v[52:55], v[228:231], v[28:31]
 ds_read_b64_tr_b16 v[70:71], v9 offset:20480
 s_add_u32 m0, s54, 114688
 s_add_u32 s60, s57, 395264
 buffer_load_dwordx4 v4, s[12:15], s60 offen lds
 v_rcp_f32 v45, v45
 s_waitcnt lgkmcnt(6)
 v_mfma_f32_16x16x32_bf16 v[20:23], v[56:59], v[168:171], v[20:23]
 ds_read_b64_tr_b16 v[72:73], v8 offset:24576
 v_rcp_f32 v46, v46
 v_rcp_f32 v47, v47
 v_mfma_f32_16x16x32_bf16 v[28:31], v[56:59], v[232:235], v[28:31]
 ds_read_b64_tr_b16 v[74:75], v9 offset:24576
 v_mul_f32 v16, v16, v40
 v_mul_f32 v17, v17, v41
 s_waitcnt lgkmcnt(6)
 v_mfma_f32_16x16x32_bf16 v[20:23], v[60:63], v[172:175], v[20:23]
 ds_read_b64_tr_b16 v[76:77], v8 offset:28672
 v_mul_f32 v18, v18, v42
 v_mul_f32 v19, v19, v43
 v_mul_f32 v24, v24, v44
 v_mfma_f32_16x16x32_bf16 v[28:31], v[60:63], v[236:239], v[28:31]
 ds_read_b64_tr_b16 v[78:79], v9 offset:28672
 s_add_u32 m0, s54, 122880
 s_add_u32 s60, s57, 591872
 buffer_load_dwordx4 v4, s[12:15], s60 offen lds
 v_mul_f32 v25, v25, v45
 v_mul_f32 v26, v26, v46
 v_mul_f32 v27, v27, v47
 s_waitcnt vmcnt(8)
 s_waitcnt lgkmcnt(0)
 s_barrier
 v_add_u32 v8, 0xffff0000, v8
 v_add_u32 v9, 0xffff0000, v9
 v_mfma_f32_16x16x32_bf16 v[20:23], v[64:67], v[176:179], v[20:23]
 ds_read_b64_tr_b16 v[48:49], v8 offset:0
 v_mul_f32 v33, v16, v16
 v_mul_f32 v35, v24, v24
 v_add_f32 v32, v16, v17
 v_mfma_f32_16x16x32_bf16 v[28:31], v[64:67], v[240:243], v[28:31]
 ds_read_b64_tr_b16 v[50:51], v9 offset:0
 v_fmac_f32 v33, v17, v17
 v_add_f32 v34, v24, v25
 v_fmac_f32 v35, v25, v25
 v_mfma_f32_16x16x32_bf16 v[20:23], v[68:71], v[180:183], v[20:23]
 ds_read_b64_tr_b16 v[52:53], v8 offset:4096
 v_add_f32 v32, v32, v18
 v_fmac_f32 v33, v18, v18
 v_add_f32 v34, v34, v26
 v_mfma_f32_16x16x32_bf16 v[28:31], v[68:71], v[244:247], v[28:31]
 ds_read_b64_tr_b16 v[54:55], v9 offset:4096
 s_add_u32 m0, s54, 65536
 s_add_u32 s60, s73, 2048
 buffer_load_dwordx4 v4, s[12:15], s60 offen lds
 v_fmac_f32 v35, v26, v26
 v_add_f32 v32, v32, v19
 v_fmac_f32 v33, v19, v19
 v_mfma_f32_16x16x32_bf16 v[20:23], v[72:75], v[184:187], v[20:23]
 ds_read_b64_tr_b16 v[56:57], v8 offset:8192
 v_add_f32 v34, v34, v27
 v_fmac_f32 v35, v27, v27
 v_mfma_f32_16x16x32_bf16 v[28:31], v[72:75], v[248:251], v[28:31]
 ds_read_b64_tr_b16 v[58:59], v9 offset:8192
 v_mfma_f32_16x16x32_bf16 v[20:23], v[76:79], v[188:191], v[20:23]
 ds_read_b64_tr_b16 v[60:61], v8 offset:12288
 v_mfma_f32_16x16x32_bf16 v[28:31], v[76:79], v[252:255], v[28:31]
 ds_read_b64_tr_b16 v[62:63], v9 offset:12288
 s_add_u32 m0, s54, 73728
 s_add_u32 s60, s73, 198656
 buffer_load_dwordx4 v4, s[12:15], s60 offen lds
 s_waitcnt lgkmcnt(6)
 v_mfma_f32_16x16x32_bf16 v[96:99], v[48:51], v[128:131], 0
 ds_read_b64_tr_b16 v[64:65], v8 offset:16384
 v_mul_f32 v40, v20, v20
 v_mul_f32 v41, v21, v21
 v_mul_f32 v42, v22, v22
 v_mul_f32 v43, v23, v23
 v_mul_f32 v44, v28, v28
 v_mul_f32 v45, v29, v29
 v_mul_f32 v46, v30, v30
 v_mul_f32 v47, v31, v31
 v_fmamk_f32 v40, v40, 0xbdd2d3e8, v15
 v_fmamk_f32 v41, v41, 0xbdd2d3e8, v15
 v_fmamk_f32 v42, v42, 0xbdd2d3e8, v15
 v_fmamk_f32 v43, v43, 0xbdd2d3e8, v15
 v_fmamk_f32 v44, v44, 0xbdd2d3e8, v15
 v_mfma_f32_16x16x32_bf16 v[100:103], v[48:51], v[192:195], 0
 ds_read_b64_tr_b16 v[66:67], v9 offset:16384
 v_fmamk_f32 v45, v45, 0xbdd2d3e8, v15
 v_fmamk_f32 v46, v46, 0xbdd2d3e8, v15
 v_fmamk_f32 v47, v47, 0xbdd2d3e8, v15
 v_mul_f32 v40, v40, v20
 v_mul_f32 v41, v41, v21
 v_mul_f32 v42, v42, v22
 v_mul_f32 v43, v43, v23
 v_mul_f32 v44, v44, v28
 v_mul_f32 v45, v45, v29
 v_mul_f32 v46, v46, v30
 v_mul_f32 v47, v47, v31
 v_exp_f32 v40, v40
 s_waitcnt lgkmcnt(6)
 v_mfma_f32_16x16x32_bf16 v[96:99], v[52:55], v[132:135], v[96:99]
 ds_read_b64_tr_b16 v[68:69], v8 offset:20480
 v_exp_f32 v41, v41
 v_exp_f32 v42, v42
 v_exp_f32 v43, v43
 v_exp_f32 v44, v44
 v_exp_f32 v45, v45
 v_exp_f32 v46, v46
 v_exp_f32 v47, v47
 v_mfma_f32_16x16x32_bf16 v[100:103], v[52:55], v[196:199], v[100:103]
 ds_read_b64_tr_b16 v[70:71], v9 offset:20480
 s_add_u32 m0, s54, 81920
 s_add_u32 s60, s73, 395264
 buffer_load_dwordx4 v4, s[12:15], s60 offen lds
 v_add_f32 v40, 1.0, v40
 v_add_f32 v41, 1.0, v41
 v_add_f32 v42, 1.0, v42
 v_add_f32 v43, 1.0, v43
 v_add_f32 v44, 1.0, v44
 v_add_f32 v45, 1.0, v45
 v_add_f32 v46, 1.0, v46
 v_add_f32 v47, 1.0, v47
 v_rcp_f32 v40, v40
 v_rcp_f32 v41, v41
 s_waitcnt lgkmcnt(6)
 v_mfma_f32_16x16x32_bf16 v[96:99], v[56:59], v[136:139], v[96:99]
 ds_read_b64_tr_b16 v[72:73], v8 offset:24576
 v_rcp_f32 v42, v42
 v_rcp_f32 v43, v43
 v_rcp_f32 v44, v44
 v_rcp_f32 v45, v45
 v_rcp_f32 v46, v46
 v_rcp_f32 v47, v47
 v_mul_f32 v20, v20, v40
 v_mfma_f32_16x16x32_bf16 v[100:103], v[56:59], v[200:203], v[100:103]
 ds_read_b64_tr_b16 v[74:75], v9 offset:24576
 v_mul_f32 v21, v21, v41
 v_mul_f32 v22, v22, v42
 v_mul_f32 v23, v23, v43
 v_mul_f32 v28, v28, v44
 v_mul_f32 v29, v29, v45
 v_mul_f32 v30, v30, v46
 v_mul_f32 v31, v31, v47
 v_add_f32 v32, v32, v20
 v_fmac_f32 v33, v20, v20
 v_add_f32 v34, v34, v28
 v_fmac_f32 v35, v28, v28
 v_add_f32 v32, v32, v21
 v_fmac_f32 v33, v21, v21
 s_waitcnt lgkmcnt(6)
 v_mfma_f32_16x16x32_bf16 v[96:99], v[60:63], v[140:143], v[96:99]
 ds_read_b64_tr_b16 v[76:77], v8 offset:28672
 v_add_f32 v34, v34, v29
 v_fmac_f32 v35, v29, v29
 v_add_f32 v32, v32, v22
 v_fmac_f32 v33, v22, v22
 v_add_f32 v34, v34, v30
 v_fmac_f32 v35, v30, v30
 v_add_f32 v32, v32, v23
 v_fmac_f32 v33, v23, v23
 v_add_f32 v34, v34, v31
 v_fmac_f32 v35, v31, v31
 s_nop 0
 v_permlane16_swap_b32 v32, v34
 v_permlane16_swap_b32 v33, v35
 v_add_f32 v32, v32, v34
 v_mfma_f32_16x16x32_bf16 v[100:103], v[60:63], v[204:207], v[100:103]
 ds_read_b64_tr_b16 v[78:79], v9 offset:28672
 s_add_u32 m0, s54, 90112
 s_add_u32 s60, s73, 591872
 buffer_load_dwordx4 v4, s[12:15], s60 offen lds
 v_add_f32 v33, v33, v35
 s_nop 1
 v_permlane32_swap_b32 v32, v33
 v_mov_b32 v35, v0
 v_add_f32 v34, v32, v33
 ds_write_b32 v10, v34
 v_lshlrev_b32 v10, 3, v1
 s_lshr_b32 s80, s81, 2
 s_lshl_b32 s80, s80, 9
 s_add_u32 s80, s80, 14680064
 s_waitcnt vmcnt(8)
 s_waitcnt lgkmcnt(0)
 s_barrier
 v_mfma_f32_16x16x32_bf16 v[96:99], v[64:67], v[144:147], v[96:99]
 ds_read_b64_tr_b16 v[48:49], v8 offset:32768
 ds_read2st64_b32 v[32:33], v11 offset0:0 offset1:1
 ds_read2st64_b32 v[36:37], v11 offset0:2 offset1:3
 v_mfma_f32_16x16x32_bf16 v[100:103], v[64:67], v[208:211], v[100:103]
 ds_read_b64_tr_b16 v[50:51], v9 offset:32768
 v_mfma_f32_16x16x32_bf16 v[96:99], v[68:71], v[148:151], v[96:99]
 ds_read_b64_tr_b16 v[52:53], v8 offset:36864
 s_waitcnt lgkmcnt(2)
 v_add_f32 v32, v32, v33
 v_add_f32 v36, v36, v37
 v_add_f32 v34, v32, v36
 s_cmp_lg_u32 s52, 0
 s_cbranch_scc1 L_g_5
 buffer_store_dwordx2 v[34:35], v10, s[44:47], s80 offen sc1
L_g_5:
 v_and_b32 v120, 0x1f0, v2
 v_mfma_f32_16x16x32_bf16 v[100:103], v[68:71], v[212:215], v[100:103]
 ds_read_b64_tr_b16 v[54:55], v9 offset:36864
 s_add_u32 m0, s54, 0
 s_add_u32 s60, s57, 0
 buffer_load_dwordx4 v4, s[12:15], s60 offen lds
 v_lshrrev_b32 v121, 5, v1
 v_lshl_add_u32 v13, v121, 11, v120
 v_mfma_f32_16x16x32_bf16 v[96:99], v[72:75], v[152:155], v[96:99]
 ds_read_b64_tr_b16 v[56:57], v8 offset:40960
 s_lshl_b32 s62, s51, 8
 s_add_u32 s62, s62, 147456
 v_lshl_add_u32 v14, v1, 2, s62
 s_add_u32 s62, s54, 139264
 v_lshl_add_u32 v10, v1, 3, s62
 v_mfma_f32_16x16x32_bf16 v[100:103], v[72:75], v[216:219], v[100:103]
 ds_read_b64_tr_b16 v[58:59], v9 offset:40960
 v_and_b32 v120, 7, v1
 v_lshrrev_b32 v121, 4, v1
 v_mfma_f32_16x16x32_bf16 v[96:99], v[76:79], v[156:159], v[96:99]
 ds_read_b64_tr_b16 v[60:61], v8 offset:45056
 v_lshlrev_b32 v121, 2, v121
 v_lshl_add_u32 v120, v120, 4, v121
 v_mfma_f32_16x16x32_bf16 v[100:103], v[76:79], v[220:223], v[100:103]
 ds_read_b64_tr_b16 v[62:63], v9 offset:45056
 s_add_u32 m0, s54, 8192
 s_add_u32 s60, s57, 196608
 buffer_load_dwordx4 v4, s[12:15], s60 offen lds
 v_bfe_u32 v121, v1, 3, 1
 v_add_u32 v120, v120, v121
 s_waitcnt lgkmcnt(6)
 v_mfma_f32_16x16x32_bf16 v[96:99], v[48:51], v[160:163], v[96:99]
 ds_read_b64_tr_b16 v[64:65], v8 offset:49152
 s_add_u32 s62, s54, 139264
 v_lshl_add_u32 v11, v120, 3, s62
 v_mfma_f32_16x16x32_bf16 v[100:103], v[48:51], v[224:227], v[100:103]
 ds_read_b64_tr_b16 v[66:67], v9 offset:49152
 s_waitcnt lgkmcnt(6)
 v_mfma_f32_16x16x32_bf16 v[96:99], v[52:55], v[164:167], v[96:99]
 ds_read_b64_tr_b16 v[68:69], v8 offset:53248
 v_mfma_f32_16x16x32_bf16 v[100:103], v[52:55], v[228:231], v[100:103]
 ds_read_b64_tr_b16 v[70:71], v9 offset:53248
 s_add_u32 m0, s54, 16384
 s_add_u32 s60, s57, 393216
 buffer_load_dwordx4 v4, s[12:15], s60 offen lds
 s_waitcnt lgkmcnt(6)
 v_mfma_f32_16x16x32_bf16 v[96:99], v[56:59], v[168:171], v[96:99]
 ds_read_b64_tr_b16 v[72:73], v8 offset:57344
 v_mfma_f32_16x16x32_bf16 v[100:103], v[56:59], v[232:235], v[100:103]
 ds_read_b64_tr_b16 v[74:75], v9 offset:57344
 s_waitcnt lgkmcnt(6)
 v_mfma_f32_16x16x32_bf16 v[96:99], v[60:63], v[172:175], v[96:99]
 ds_read_b64_tr_b16 v[76:77], v8 offset:61440
 v_mfma_f32_16x16x32_bf16 v[100:103], v[60:63], v[236:239], v[100:103]
 ds_read_b64_tr_b16 v[78:79], v9 offset:61440
 s_add_u32 m0, s54, 24576
 s_add_u32 s60, s57, 589824
 buffer_load_dwordx4 v4, s[12:15], s60 offen lds
 s_waitcnt vmcnt(8)
 s_waitcnt lgkmcnt(0)
 s_barrier
 v_add_u32 v8, 0x10000, v8
 v_add_u32 v9, 0x10000, v9
 v_mfma_f32_16x16x32_bf16 v[96:99], v[64:67], v[176:179], v[96:99]
 ds_read_b64_tr_b16 v[48:49], v8 offset:32768
 v_mfma_f32_16x16x32_bf16 v[100:103], v[64:67], v[240:243], v[100:103]
 ds_read_b64_tr_b16 v[50:51], v9 offset:32768
 v_mfma_f32_16x16x32_bf16 v[96:99], v[68:71], v[180:183], v[96:99]
 ds_read_b64_tr_b16 v[52:53], v8 offset:36864
 v_mfma_f32_16x16x32_bf16 v[100:103], v[68:71], v[244:247], v[100:103]
 ds_read_b64_tr_b16 v[54:55], v9 offset:36864
 s_add_u32 m0, s54, 32768
 s_add_u32 s60, s73, 0
 buffer_load_dwordx4 v4, s[12:15], s60 offen lds
 v_mfma_f32_16x16x32_bf16 v[96:99], v[72:75], v[184:187], v[96:99]
 ds_read_b64_tr_b16 v[56:57], v8 offset:40960
 v_mfma_f32_16x16x32_bf16 v[100:103], v[72:75], v[248:251], v[100:103]
 ds_read_b64_tr_b16 v[58:59], v9 offset:40960
 v_mfma_f32_16x16x32_bf16 v[96:99], v[76:79], v[188:191], v[96:99]
 ds_read_b64_tr_b16 v[60:61], v8 offset:45056
 v_mfma_f32_16x16x32_bf16 v[100:103], v[76:79], v[252:255], v[100:103]
 ds_read_b64_tr_b16 v[62:63], v9 offset:45056
 s_add_u32 m0, s54, 40960
 s_add_u32 s60, s73, 196608
 buffer_load_dwordx4 v4, s[12:15], s60 offen lds
 s_waitcnt lgkmcnt(6)
 v_mfma_f32_16x16x32_bf16 v[104:107], v[128:131], v[48:51], 0
 ds_read_b64_tr_b16 v[64:65], v8 offset:49152
 v_cvt_pk_bf16_f32 v80, v96, v97
 v_cvt_pk_bf16_f32 v81, v98, v99
 v_mfma_f32_16x16x32_bf16 v[108:111], v[192:195], v[48:51], 0
 ds_read_b64_tr_b16 v[66:67], v9 offset:49152
 v_cvt_pk_bf16_f32 v82, v100, v101
 v_cvt_pk_bf16_f32 v83, v102, v103
 s_waitcnt lgkmcnt(6)
 v_mfma_f32_16x16x32_bf16 v[104:107], v[132:135], v[52:55], v[104:107]
 ds_read_b64_tr_b16 v[68:69], v8 offset:53248
 v_mfma_f32_16x16x32_bf16 v[108:111], v[196:199], v[52:55], v[108:111]
 ds_read_b64_tr_b16 v[70:71], v9 offset:53248
 s_add_u32 m0, s54, 49152
 s_add_u32 s60, s73, 393216
 buffer_load_dwordx4 v4, s[12:15], s60 offen lds
 s_waitcnt lgkmcnt(6)
 v_mfma_f32_16x16x32_bf16 v[104:107], v[136:139], v[56:59], v[104:107]
 ds_read_b64_tr_b16 v[72:73], v8 offset:57344
 v_mfma_f32_16x16x32_bf16 v[108:111], v[200:203], v[56:59], v[108:111]
 ds_read_b64_tr_b16 v[74:75], v9 offset:57344
 s_waitcnt lgkmcnt(6)
 v_mfma_f32_16x16x32_bf16 v[104:107], v[140:143], v[60:63], v[104:107]
 ds_read_b64_tr_b16 v[76:77], v8 offset:61440
 v_mfma_f32_16x16x32_bf16 v[108:111], v[204:207], v[60:63], v[108:111]
 ds_read_b64_tr_b16 v[78:79], v9 offset:61440
 s_add_u32 m0, s54, 57344
 s_add_u32 s60, s73, 589824
 buffer_load_dwordx4 v4, s[12:15], s60 offen lds
 s_min_u32 s63, s50, 6
 s_lshl_b32 s72, s48, 3
 s_add_u32 s72, s72, s63
 s_lshl_b32 s72, s72, 10
 s_add_u32 s72, s72, 14680064
 buffer_load_dwordx4 v[32:35], v2, s[44:47], s72 offen sc1
 s_waitcnt vmcnt(9)
 s_waitcnt lgkmcnt(0)
 s_barrier
 v_mfma_f32_16x16x32_bf16 v[104:107], v[144:147], v[64:67], v[104:107]
 ds_read_b64_tr_b16 v[48:49], v8 offset:0
 v_mfma_f32_16x16x32_bf16 v[108:111], v[208:211], v[64:67], v[108:111]
 ds_read_b64_tr_b16 v[50:51], v9 offset:0
 v_mfma_f32_16x16x32_bf16 v[104:107], v[148:151], v[68:71], v[104:107]
 ds_read_b64_tr_b16 v[52:53], v8 offset:4096
 v_mfma_f32_16x16x32_bf16 v[108:111], v[212:215], v[68:71], v[108:111]
 ds_read_b64_tr_b16 v[54:55], v9 offset:4096
 s_xor_b32 s71, s3, 0
 s_add_u32 s71, s71, s55
 s_add_u32 m0, s54, 98304
 s_add_u32 s60, s71, 0
 buffer_load_dwordx4 v3, s[20:23], s60 offen lds
 v_mfma_f32_16x16x32_bf16 v[104:107], v[152:155], v[72:75], v[104:107]
 ds_read_b64_tr_b16 v[56:57], v8 offset:8192
 v_mfma_f32_16x16x32_bf16 v[108:111], v[216:219], v[72:75], v[108:111]
 ds_read_b64_tr_b16 v[58:59], v9 offset:8192
 v_mfma_f32_16x16x32_bf16 v[104:107], v[156:159], v[76:79], v[104:107]
 ds_read_b64_tr_b16 v[60:61], v8 offset:12288
 v_mfma_f32_16x16x32_bf16 v[108:111], v[220:223], v[76:79], v[108:111]
 ds_read_b64_tr_b16 v[62:63], v9 offset:12288
 s_add_u32 m0, s54, 106496
 s_add_u32 s60, s71, 229376
 buffer_load_dwordx4 v3, s[20:23], s60 offen lds
 s_waitcnt lgkmcnt(6)
 v_mfma_f32_16x16x32_bf16 v[104:107], v[160:163], v[48:51], v[104:107]
 ds_read_b64_tr_b16 v[64:65], v8 offset:16384
 v_mfma_f32_16x16x32_bf16 v[108:111], v[224:227], v[48:51], v[108:111]
 ds_read_b64_tr_b16 v[66:67], v9 offset:16384
 s_waitcnt lgkmcnt(6)
 v_mfma_f32_16x16x32_bf16 v[104:107], v[164:167], v[52:55], v[104:107]
 ds_read_b64_tr_b16 v[68:69], v8 offset:20480
 v_mfma_f32_16x16x32_bf16 v[108:111], v[228:231], v[52:55], v[108:111]
 ds_read_b64_tr_b16 v[70:71], v9 offset:20480
 s_add_u32 m0, s54, 114688
 s_add_u32 s60, s71, 458752
 buffer_load_dwordx4 v3, s[20:23], s60 offen lds
 s_waitcnt lgkmcnt(6)
 v_mfma_f32_16x16x32_bf16 v[104:107], v[168:171], v[56:59], v[104:107]
 ds_read_b64_tr_b16 v[72:73], v8 offset:24576
 v_mfma_f32_16x16x32_bf16 v[108:111], v[232:235], v[56:59], v[108:111]
 ds_read_b64_tr_b16 v[74:75], v9 offset:24576
 s_waitcnt lgkmcnt(6)
 v_mfma_f32_16x16x32_bf16 v[104:107], v[172:175], v[60:63], v[104:107]
 ds_read_b64_tr_b16 v[76:77], v8 offset:28672
 v_mfma_f32_16x16x32_bf16 v[108:111], v[236:239], v[60:63], v[108:111]
 ds_read_b64_tr_b16 v[78:79], v9 offset:28672
 s_add_u32 m0, s54, 122880
 s_add_u32 s60, s71, 688128
 buffer_load_dwordx4 v3, s[20:23], s60 offen lds
 s_mul_i32 s62, s48, 7
 s_add_u32 s62, s62, s49
 s_lshl_b32 s62, s62, 3
 s_add_u32 s62, s62, s50
 s_mul_i32 s63, s62, 384
 s_lshl_b32 s62, s62, 9
 v_lshlrev_b32 v124, 7, v1
 s_mov_b64 exec, 0x7
 buffer_load_dword v12, v124, s[16:19], s63 offen
 s_mov_b64 exec, 0xf
 buffer_load_dword v12, v124, s[32:35], s62 offen
 s_mov_b64 exec, -1
 s_and_b32 s62, s81, 63
 s_mul_i32 s62, s62, 5
 s_add_u32 s62, s62, 744
 v_add_u32 v124, s62, v1
 v_min_u32 v124, 1023, v124
 v_lshrrev_b32 v125, 4, v124
 v_and_b32 v126, 15, v124
 v_lshlrev_b32 v125, 12, v125
 v_lshl_add_u32 v125, v126, 7, v125
 v_xor_b32 v124, s48, v124
 v_and_b32 v124, 1, v124
 v_lshl_add_u32 v125, v124, 11, v125
 s_lshl_b32 s62, s48, 18
 s_mov_b64 exec, 0x1f
 buffer_load_dword v12, v125, s[24:27], s62 offen
 s_mov_b64 exec, -1
 s_waitcnt vmcnt(7)
 v_bitop3_b32 v120, v33, v35, v0 bitop3:0x7e
 v_cmp_ne_u32 vcc, 0, v120
 s_cbranch_vccz L_ok_6
 s_mov_b32 s70, 50000
L_spin_7:
 s_sleep 1
 buffer_load_dwordx4 v[32:35], v2, s[44:47], s72 offen sc1
 s_waitcnt vmcnt(0)
 s_sub_u32 s70, s70, 1
 s_cbranch_scc1 L_ok_6
 v_bitop3_b32 v120, v33, v35, v0 bitop3:0x7e
 v_cmp_ne_u32 vcc, 0, v120
 s_cbranch_vccnz L_spin_7
L_ok_6:
 s_lshl_b32 s62, s50, 9
 s_add_u32 s62, s62, 147456
 v_lshl_add_u32 v122, v1, 3, s62
 v_mov_b32 v33, v34
 ds_write_b64 v122, v[32:33]
 s_waitcnt lgkmcnt(0)
 s_barrier
 v_add_u32 v8, 0xffff0000, v8
 v_add_u32 v9, 0xffff0000, v9
 v_mfma_f32_16x16x32_bf16 v[104:107], v[176:179], v[64:67], v[104:107]
 ds_read_b64_tr_b16 v[48:49], v8 offset:0
 ds_read2st64_b32 v[40:41], v14 offset0:0 offset1:2
 ds_read2st64_b32 v[42:43], v14 offset0:4 offset1:6
 ds_read2st64_b32 v[44:45], v14 offset0:8 offset1:10
 ds_read_b32 v46, v14 offset:3072
 s_lshl_b32 s80, s49, 19
 s_lshl_b32 s63, s48, 14
 s_add_u32 s80, s80, s63
 s_lshl_b32 s63, s50, 11
 s_add_u32 s80, s80, s63
 s_lshl_b32 s63, s3, 3
 s_add_u32 s80, s80, s63
 s_xor_b32 s72, s80, 1024
 v_mfma_f32_16x16x32_bf16 v[108:111], v[240:243], v[64:67], v[108:111]
 ds_read_b64_tr_b16 v[50:51], v9 offset:0
 s_waitcnt lgkmcnt(1)
 v_add_f32 v40, v40, v41
 v_add_f32 v42, v42, v43
 v_add_f32 v44, v44, v45
 v_add_f32 v40, v40, v42
 v_add_f32 v44, v44, v46
 v_add_f32 v32, v40, v44
 v_add_f32 v33, v40, v44
 v_mfma_f32_16x16x32_bf16 v[104:107], v[180:183], v[68:71], v[104:107]
 ds_read_b64_tr_b16 v[52:53], v8 offset:4096
 v_permlane32_swap_b32 v32, v33
 v_mul_f32 v32, 0xba924925, v32
 v_mul_f32 v33, 0x3a924925, v33
 v_fma_f32 v33, -v32, v32, v33
 v_max_f32 v33, 0, v33
 v_add_f32 v33, 0x3727c5ac, v33
 v_rsq_f32 v36, v33
 s_nop 0
 v_mul_f32 v38, v32, v36
 v_mfma_f32_16x16x32_bf16 v[108:111], v[244:247], v[68:71], v[108:111]
 ds_read_b64_tr_b16 v[54:55], v9 offset:4096
 s_xor_b32 s71, s3, 0
 s_add_u32 s71, s71, s56
 s_add_u32 m0, s54, 65536
 s_add_u32 s60, s71, 0
 buffer_load_dwordx4 v3, s[20:23], s60 offen lds
 v_mov_b32 v37, v36
 v_mov_b32 v39, v38
 s_nop 0
 v_permlane16_swap_b32 v36, v37
 v_permlane16_swap_b32 v38, v39
 v_fma_f32 v16, v16, v36, v38
 v_fma_f32 v17, v17, v36, v38
 v_fma_f32 v18, v18, v36, v38
 v_fma_f32 v19, v19, v36, v38
 v_mfma_f32_16x16x32_bf16 v[104:107], v[184:187], v[72:75], v[104:107]
 ds_read_b64_tr_b16 v[56:57], v8 offset:8192
 v_cvt_pk_bf16_f32 v16, v16, v17
 v_cvt_pk_bf16_f32 v17, v18, v19
 ds_write_b64 v10, v[16:17] offset:0
 v_fma_f32 v24, v24, v37, v39
 v_fma_f32 v25, v25, v37, v39
 v_fma_f32 v26, v26, v37, v39
 v_fma_f32 v27, v27, v37, v39
 v_cvt_pk_bf16_f32 v24, v24, v25
 v_cvt_pk_bf16_f32 v25, v26, v27
 v_mfma_f32_16x16x32_bf16 v[108:111], v[248:251], v[72:75], v[108:111]
 ds_read_b64_tr_b16 v[58:59], v9 offset:8192
 ds_write_b64 v10, v[24:25] offset:512
 ds_read_b64_tr_b16 v[120:121], v11 offset:0
 ds_read_b64_tr_b16 v[122:123], v11 offset:16
 v_fma_f32 v20, v20, v36, v38
 v_fma_f32 v21, v21, v36, v38
 v_fma_f32 v22, v22, v36, v38
 v_fma_f32 v23, v23, v36, v38
 v_cvt_pk_bf16_f32 v20, v20, v21
 v_cvt_pk_bf16_f32 v21, v22, v23
 s_waitcnt lgkmcnt(0)
 buffer_store_dwordx4 v[120:123], v2, s[44:47], s80 offen sc1
 ds_write_b64 v10, v[20:21] offset:0
 v_fma_f32 v28, v28, v37, v39
 v_fma_f32 v29, v29, v37, v39
 v_mfma_f32_16x16x32_bf16 v[104:107], v[188:191], v[76:79], v[104:107]
 ds_read_b64_tr_b16 v[60:61], v8 offset:12288
 v_fma_f32 v30, v30, v37, v39
 v_fma_f32 v31, v31, v37, v39
 v_cvt_pk_bf16_f32 v28, v28, v29
 v_cvt_pk_bf16_f32 v29, v30, v31
 ds_write_b64 v10, v[28:29] offset:512
 ds_read_b64_tr_b16 v[124:125], v11 offset:0
 ds_read_b64_tr_b16 v[126:127], v11 offset:16
 s_waitcnt lgkmcnt(0)
 buffer_store_dwordx4 v[124:127], v2, s[44:47], s72 offen sc1
 v_mfma_f32_16x16x32_bf16 v[108:111], v[252:255], v[76:79], v[108:111]
 ds_read_b64_tr_b16 v[62:63], v9 offset:12288
 s_add_u32 m0, s54, 73728
 s_add_u32 s60, s71, 229376
 buffer_load_dwordx4 v3, s[20:23], s60 offen lds
 v_mfma_f32_16x16x32_bf16 v[112:115], v[48:51], v[128:131], 0
 ds_read_b64_tr_b16 v[64:65], v8 offset:16384
 v_cvt_pk_bf16_f32 v84, v104, v105
 v_cvt_pk_bf16_f32 v85, v106, v107
 v_mfma_f32_16x16x32_bf16 v[116:119], v[48:51], v[192:195], 0
 ds_read_b64_tr_b16 v[66:67], v9 offset:16384
 v_cvt_pk_bf16_f32 v86, v108, v109
 v_cvt_pk_bf16_f32 v87, v110, v111
 v_mfma_f32_16x16x32_bf16 v[112:115], v[52:55], v[132:135], v[112:115]
 ds_read_b64_tr_b16 v[68:69], v8 offset:20480
 s_lshl_b32 s62, s52, 11
 s_add_u32 s62, s62, 131072
 v_add_u32 v92, s62, v2
 s_lshl_b32 s62, s81, 11
 s_add_u32 s62, s62, 20971520
 s_cmp_eq_u32 s51, 0
 s_cbranch_scc1 L_kv_8
 s_mov_b32 exec_lo, 0xff00ff00
 s_mov_b32 exec_hi, 0xff00ff00
 buffer_store_dwordx4 v[80:83], v2, s[44:47], s62 offen sc1
 s_mov_b32 exec_lo, 0
 s_mov_b32 exec_hi, -1
 buffer_store_dwordx4 v[84:87], v2, s[44:47], s62 offen offset:1024 sc1
 s_mov_b64 exec, -1
 s_branch L_kv_9
L_kv_8:
 ds_write_b128 v92, v[80:83]
 ds_write_b128 v92, v[84:87] offset:1024
L_kv_9:
 v_mfma_f32_16x16x32_bf16 v[116:119], v[52:55], v[196:199], v[116:119]
 ds_read_b64_tr_b16 v[70:71], v9 offset:20480
 s_add_u32 m0, s54, 81920
 s_add_u32 s60, s71, 458752
 buffer_load_dwordx4 v3, s[20:23], s60 offen lds
 v_mfma_f32_16x16x32_bf16 v[112:115], v[56:59], v[136:139], v[112:115]
 ds_read_b64_tr_b16 v[72:73], v8 offset:24576
 v_mfma_f32_16x16x32_bf16 v[116:119], v[56:59], v[200:203], v[116:119]
 ds_read_b64_tr_b16 v[74:75], v9 offset:24576
 s_waitcnt lgkmcnt(6)
 v_mfma_f32_16x16x32_bf16 v[112:115], v[60:63], v[140:143], v[112:115]
 ds_read_b64_tr_b16 v[76:77], v8 offset:28672
 v_mfma_f32_16x16x32_bf16 v[116:119], v[60:63], v[204:207], v[116:119]
 ds_read_b64_tr_b16 v[78:79], v9 offset:28672
 s_add_u32 m0, s54, 90112
 s_add_u32 s60, s71, 688128
 buffer_load_dwordx4 v3, s[20:23], s60 offen lds
 s_waitcnt lgkmcnt(0)
 s_barrier
 v_mfma_f32_16x16x32_bf16 v[112:115], v[64:67], v[144:147], v[112:115]
 ds_read_b64_tr_b16 v[48:49], v8 offset:32768
 v_mfma_f32_16x16x32_bf16 v[116:119], v[64:67], v[208:211], v[116:119]
 ds_read_b64_tr_b16 v[50:51], v9 offset:32768
 v_mfma_f32_16x16x32_bf16 v[112:115], v[68:71], v[148:151], v[112:115]
 ds_read_b64_tr_b16 v[52:53], v8 offset:36864
 v_mfma_f32_16x16x32_bf16 v[116:119], v[68:71], v[212:215], v[116:119]
 ds_read_b64_tr_b16 v[54:55], v9 offset:36864
 s_xor_b32 s71, s3, 128
 s_add_u32 s71, s71, s55
 s_add_u32 m0, s54, 0
 s_add_u32 s60, s71, 0
 buffer_load_dwordx4 v3, s[20:23], s60 offen lds
 v_mfma_f32_16x16x32_bf16 v[112:115], v[72:75], v[152:155], v[112:115]
 ds_read_b64_tr_b16 v[56:57], v8 offset:40960
 v_mfma_f32_16x16x32_bf16 v[116:119], v[72:75], v[216:219], v[116:119]
 ds_read_b64_tr_b16 v[58:59], v9 offset:40960
 v_mfma_f32_16x16x32_bf16 v[112:115], v[76:79], v[156:159], v[112:115]
 ds_read_b64_tr_b16 v[60:61], v8 offset:45056
 v_mfma_f32_16x16x32_bf16 v[116:119], v[76:79], v[220:223], v[116:119]
 ds_read_b64_tr_b16 v[62:63], v9 offset:45056
 s_add_u32 m0, s54, 8192
 s_add_u32 s60, s71, 229376
 buffer_load_dwordx4 v3, s[20:23], s60 offen lds
 s_waitcnt lgkmcnt(6)
 v_mfma_f32_16x16x32_bf16 v[112:115], v[48:51], v[160:163], v[112:115]
 ds_read_b64_tr_b16 v[64:65], v8 offset:49152
 v_mfma_f32_16x16x32_bf16 v[116:119], v[48:51], v[224:227], v[116:119]
 ds_read_b64_tr_b16 v[66:67], v9 offset:49152
 s_waitcnt lgkmcnt(6)
 v_mfma_f32_16x16x32_bf16 v[112:115], v[52:55], v[164:167], v[112:115]
 ds_read_b64_tr_b16 v[68:69], v8 offset:53248
 v_mfma_f32_16x16x32_bf16 v[116:119], v[52:55], v[228:231], v[116:119]
 ds_read_b64_tr_b16 v[70:71], v9 offset:53248
 s_add_u32 m0, s54, 16384
 s_add_u32 s60, s71, 458752
 buffer_load_dwordx4 v3, s[20:23], s60 offen lds
 s_waitcnt lgkmcnt(6)
 v_mfma_f32_16x16x32_bf16 v[112:115], v[56:59], v[168:171], v[112:115]
 ds_read_b64_tr_b16 v[72:73], v8 offset:57344
 v_mfma_f32_16x16x32_bf16 v[116:119], v[56:59], v[232:235], v[116:119]
 ds_read_b64_tr_b16 v[74:75], v9 offset:57344
 s_waitcnt lgkmcnt(6)
 v_mfma_f32_16x16x32_bf16 v[112:115], v[60:63], v[172:175], v[112:115]
 ds_read_b64_tr_b16 v[76:77], v8 offset:61440
 v_mfma_f32_16x16x32_bf16 v[116:119], v[60:63], v[236:239], v[116:119]
 ds_read_b64_tr_b16 v[78:79], v9 offset:61440
 s_add_u32 m0, s54, 24576
 s_add_u32 s60, s71, 688128
 buffer_load_dwordx4 v3, s[20:23], s60 offen lds
 s_waitcnt vmcnt(13)
 s_waitcnt vmcnt(6)
 s_waitcnt lgkmcnt(0)
 s_barrier
 s_cmp_lg_u32 s50, 0
 s_cbranch_scc1 L_fl_10
 s_lshl_b32 s61, s81, 4
 s_add_u32 s61, s61, 12582912
 s_mov_b64 exec, 1
 buffer_store_dword v0, off, s[44:47], s61 sc1
 s_mov_b64 exec, -1
L_fl_10:
 v_add_u32 v8, 0x10000, v8
 v_add_u32 v9, 0x10000, v9
 v_mfma_f32_16x16x32_bf16 v[112:115], v[64:67], v[176:179], v[112:115]
 ds_read_b64_tr_b16 v[48:49], v8 offset:32768
 v_mfma_f32_16x16x32_bf16 v[116:119], v[64:67], v[240:243], v[116:119]
 ds_read_b64_tr_b16 v[50:51], v9 offset:32768
 v_mfma_f32_16x16x32_bf16 v[112:115], v[68:71], v[180:183], v[112:115]
 ds_read_b64_tr_b16 v[52:53], v8 offset:36864
 v_mfma_f32_16x16x32_bf16 v[116:119], v[68:71], v[244:247], v[116:119]
 ds_read_b64_tr_b16 v[54:55], v9 offset:36864
 s_xor_b32 s71, s3, 128
 s_add_u32 s71, s71, s56
 s_add_u32 m0, s54, 32768
 s_add_u32 s60, s71, 0
 buffer_load_dwordx4 v3, s[20:23], s60 offen lds
 v_mfma_f32_16x16x32_bf16 v[112:115], v[72:75], v[184:187], v[112:115]
 ds_read_b64_tr_b16 v[56:57], v8 offset:40960
 v_mfma_f32_16x16x32_bf16 v[116:119], v[72:75], v[248:251], v[116:119]
 ds_read_b64_tr_b16 v[58:59], v9 offset:40960
 v_mfma_f32_16x16x32_bf16 v[112:115], v[76:79], v[188:191], v[112:115]
 ds_read_b64_tr_b16 v[60:61], v8 offset:45056
 v_mfma_f32_16x16x32_bf16 v[116:119], v[76:79], v[252:255], v[116:119]
 ds_read_b64_tr_b16 v[62:63], v9 offset:45056
 s_add_u32 m0, s54, 40960
 s_add_u32 s60, s71, 229376
 buffer_load_dwordx4 v3, s[20:23], s60 offen lds
 s_waitcnt lgkmcnt(6)
 v_mfma_f32_16x16x32_bf16 v[32:35], v[48:51], v[128:131], 0
 ds_read_b64_tr_b16 v[64:65], v8 offset:49152
 v_cvt_pk_bf16_f32 v88, v112, v113
 v_cvt_pk_bf16_f32 v89, v114, v115
 v_mfma_f32_16x16x32_bf16 v[40:43], v[48:51], v[192:195], 0
 ds_read_b64_tr_b16 v[66:67], v9 offset:49152
 v_cvt_pk_bf16_f32 v90, v116, v117
 v_cvt_pk_bf16_f32 v91, v118, v119
 s_waitcnt lgkmcnt(6)
 v_mfma_f32_16x16x32_bf16 v[32:35], v[52:55], v[132:135], v[32:35]
 ds_read_b64_tr_b16 v[68:69], v8 offset:53248
 v_mov_b32 v16, 0
 v_mov_b32 v17, 0
 v_mfma_f32_16x16x32_bf16 v[40:43], v[52:55], v[196:199], v[40:43]
 ds_read_b64_tr_b16 v[70:71], v9 offset:53248
 s_add_u32 m0, s54, 49152
 s_add_u32 s60, s71, 458752
 buffer_load_dwordx4 v3, s[20:23], s60 offen lds
 v_mov_b32 v18, 0
 v_mov_b32 v19, 0
 s_waitcnt lgkmcnt(6)
 v_mfma_f32_16x16x32_bf16 v[32:35], v[56:59], v[136:139], v[32:35]
 ds_read_b64_tr_b16 v[72:73], v8 offset:57344
 v_mov_b32 v20, 0
 v_mov_b32 v21, 0
 v_mfma_f32_16x16x32_bf16 v[40:43], v[56:59], v[200:203], v[40:43]
 ds_read_b64_tr_b16 v[74:75], v9 offset:57344
 v_mov_b32 v22, 0
 v_mov_b32 v23, 0
 s_waitcnt lgkmcnt(6)
 v_mfma_f32_16x16x32_bf16 v[32:35], v[60:63], v[140:143], v[32:35]
 ds_read_b64_tr_b16 v[76:77], v8 offset:61440
 v_mfma_f32_16x16x32_bf16 v[40:43], v[60:63], v[204:207], v[40:43]
 ds_read_b64_tr_b16 v[78:79], v9 offset:61440
 s_add_u32 m0, s54, 57344
 s_add_u32 s60, s71, 688128
 buffer_load_dwordx4 v3, s[20:23], s60 offen lds
 s_waitcnt vmcnt(8)
 s_waitcnt lgkmcnt(0)
 s_barrier
 v_mfma_f32_16x16x32_bf16 v[32:35], v[64:67], v[144:147], v[32:35]
 ds_read_b64_tr_b16 v[48:49], v8 offset:0
 v_mfma_f32_16x16x32_bf16 v[40:43], v[64:67], v[208:211], v[40:43]
 ds_read_b64_tr_b16 v[50:51], v9 offset:0
 v_mfma_f32_16x16x32_bf16 v[32:35], v[68:71], v[148:151], v[32:35]
 ds_read_b64_tr_b16 v[52:53], v8 offset:4096
 v_mfma_f32_16x16x32_bf16 v[40:43], v[68:71], v[212:215], v[40:43]
 ds_read_b64_tr_b16 v[54:55], v9 offset:4096
 s_add_u32 m0, s54, 98304
 s_xor_b32 s60, s58, 0
 buffer_load_dwordx4 v5, s[24:27], s60 offen lds
 v_mfma_f32_16x16x32_bf16 v[32:35], v[72:75], v[152:155], v[32:35]
 ds_read_b64_tr_b16 v[56:57], v8 offset:8192
 v_mfma_f32_16x16x32_bf16 v[40:43], v[72:75], v[216:219], v[40:43]
 ds_read_b64_tr_b16 v[58:59], v9 offset:8192
 v_mfma_f32_16x16x32_bf16 v[32:35], v[76:79], v[156:159], v[32:35]
 ds_read_b64_tr_b16 v[60:61], v8 offset:12288
 v_mfma_f32_16x16x32_bf16 v[40:43], v[76:79], v[220:223], v[40:43]
 ds_read_b64_tr_b16 v[62:63], v9 offset:12288
 s_add_u32 m0, s54, 106496
 s_xor_b32 s60, s58, 2176
 buffer_load_dwordx4 v5, s[24:27], s60 offen lds
 s_waitcnt lgkmcnt(6)
 v_mfma_f32_16x16x32_bf16 v[32:35], v[48:51], v[160:163], v[32:35]
 ds_read_b64_tr_b16 v[64:65], v8 offset:16384
 v_mfma_f32_16x16x32_bf16 v[40:43], v[48:51], v[224:227], v[40:43]
 ds_read_b64_tr_b16 v[66:67], v9 offset:16384
 s_waitcnt lgkmcnt(6)
 v_mfma_f32_16x16x32_bf16 v[32:35], v[52:55], v[164:167], v[32:35]
 ds_read_b64_tr_b16 v[68:69], v8 offset:20480
 v_mfma_f32_16x16x32_bf16 v[40:43], v[52:55], v[228:231], v[40:43]
 ds_read_b64_tr_b16 v[70:71], v9 offset:20480
 s_add_u32 m0, s54, 114688
 s_xor_b32 s60, s58, 256
 buffer_load_dwordx4 v5, s[24:27], s60 offen lds
 s_waitcnt lgkmcnt(6)
 v_mfma_f32_16x16x32_bf16 v[32:35], v[56:59], v[168:171], v[32:35]
 ds_read_b64_tr_b16 v[72:73], v8 offset:24576
 v_mfma_f32_16x16x32_bf16 v[40:43], v[56:59], v[232:235], v[40:43]
 ds_read_b64_tr_b16 v[74:75], v9 offset:24576
 s_waitcnt lgkmcnt(6)
 v_mfma_f32_16x16x32_bf16 v[32:35], v[60:63], v[172:175], v[32:35]
 ds_read_b64_tr_b16 v[76:77], v8 offset:28672
 v_mfma_f32_16x16x32_bf16 v[40:43], v[60:63], v[236:239], v[40:43]
 ds_read_b64_tr_b16 v[78:79], v9 offset:28672
 s_add_u32 m0, s54, 122880
 s_xor_b32 s60, s58, 2432
 buffer_load_dwordx4 v5, s[24:27], s60 offen lds
 s_cmp_lg_u32 s50, 1
 s_cbranch_scc1 L_pi_11
 s_and_b32 s62, s48, 1
 s_lshl_b32 s62, s62, 14
 s_lshl_b32 s63, s49, 7
 s_add_u32 s62, s62, s63
 s_add_u32 s62, s62, 12582912
 v_and_b32 v13, 15, v1
 v_and_b32 v12, 1, v1
 v_lshl_add_u32 v12, v12, 4, v13
 v_lshlrev_b32 v12, 10, v12
 v_xor_b32 v13, s62, v12
 s_min_u32 s63, s48, 1
 s_lshl_b32 s63, s63, 6
 s_sub_u32 s63, s81, s63
 s_andn2_b32 s63, s63, 7
 s_lshl_b32 s63, s63, 4
 s_add_u32 s63, s63, 12582912
 v_writelane_b32 v13, s63, 0
 v_mov_b32 v12, 0
 s_mov_b64 exec, 0x1ffff
 buffer_atomic_or v12, v13, s[44:47], 0 offen sc0 sc1
 s_mov_b64 exec, -1
L_pi_11:
 s_lshl_b32 s68, s49, 19
 s_lshl_b32 s62, s50, 11
 s_add_u32 s68, s68, s62
 s_and_b32 s62, s69, 0xfff
 s_lshl_b32 s62, s62, 7
 s_add_u32 s68, s68, s62
 s_lshl_b32 s62, s3, 3
 s_add_u32 s68, s68, s62
 s_waitcnt vmcnt(8)
 s_waitcnt lgkmcnt(0)
 s_barrier
 v_add_u32 v8, 0xffff0000, v8
 v_add_u32 v9, 0xffff0000, v9
 v_mfma_f32_16x16x32_bf16 v[32:35], v[64:67], v[176:179], v[32:35]
 ds_read_b64_tr_b16 v[48:49], v8 offset:0
 v_mfma_f32_16x16x32_bf16 v[40:43], v[64:67], v[240:243], v[40:43]
 ds_read_b64_tr_b16 v[50:51], v9 offset:0
 v_mfma_f32_16x16x32_bf16 v[32:35], v[68:71], v[180:183], v[32:35]
 ds_read_b64_tr_b16 v[52:53], v8 offset:4096
 v_mfma_f32_16x16x32_bf16 v[40:43], v[68:71], v[244:247], v[40:43]
 ds_read_b64_tr_b16 v[54:55], v9 offset:4096
 s_add_u32 m0, s54, 65536
 s_xor_b32 s60, s58, 512
 buffer_load_dwordx4 v5, s[24:27], s60 offen lds
 v_mfma_f32_16x16x32_bf16 v[32:35], v[72:75], v[184:187], v[32:35]
 ds_read_b64_tr_b16 v[56:57], v8 offset:8192
 v_mfma_f32_16x16x32_bf16 v[40:43], v[72:75], v[248:251], v[40:43]
 ds_read_b64_tr_b16 v[58:59], v9 offset:8192
 v_mfma_f32_16x16x32_bf16 v[32:35], v[76:79], v[188:191], v[32:35]
 ds_read_b64_tr_b16 v[60:61], v8 offset:12288
 v_mfma_f32_16x16x32_bf16 v[40:43], v[76:79], v[252:255], v[40:43]
 ds_read_b64_tr_b16 v[62:63], v9 offset:12288
 s_add_u32 m0, s54, 73728
 s_xor_b32 s60, s58, 2688
 buffer_load_dwordx4 v5, s[24:27], s60 offen lds
 s_waitcnt lgkmcnt(6)
 v_mfma_f32_16x16x32_bf16 v[36:39], v[48:51], v[128:131], 0
 ds_read_b64_tr_b16 v[64:65], v8 offset:16384
 v_mul_f32 v96, v32, v32
 v_mul_f32 v97, v33, v33
 v_mfma_f32_16x16x32_bf16 v[44:47], v[48:51], v[192:195], 0
 ds_read_b64_tr_b16 v[66:67], v9 offset:16384
 v_mul_f32 v98, v34, v34
 v_mul_f32 v99, v35, v35
 s_waitcnt lgkmcnt(6)
 v_mfma_f32_16x16x32_bf16 v[36:39], v[52:55], v[132:135], v[36:39]
 ds_read_b64_tr_b16 v[68:69], v8 offset:20480
 v_mul_f32 v100, v40, v40
 v_mul_f32 v101, v41, v41
 v_mfma_f32_16x16x32_bf16 v[44:47], v[52:55], v[196:199], v[44:47]
 ds_read_b64_tr_b16 v[70:71], v9 offset:20480
 s_add_u32 m0, s54, 81920
 s_xor_b32 s60, s58, 768
 buffer_load_dwordx4 v5, s[24:27], s60 offen lds
 v_mul_f32 v102, v42, v42
 v_mul_f32 v103, v43, v43
 s_waitcnt lgkmcnt(6)
 v_mfma_f32_16x16x32_bf16 v[36:39], v[56:59], v[136:139], v[36:39]
 ds_read_b64_tr_b16 v[72:73], v8 offset:24576
 v_fmamk_f32 v96, v96, 0xbdd2d3e8, v15
 v_fmamk_f32 v97, v97, 0xbdd2d3e8, v15
 v_mfma_f32_16x16x32_bf16 v[44:47], v[56:59], v[200:203], v[44:47]
 ds_read_b64_tr_b16 v[74:75], v9 offset:24576
 v_fmamk_f32 v98, v98, 0xbdd2d3e8, v15
 v_fmamk_f32 v99, v99, 0xbdd2d3e8, v15
 s_waitcnt lgkmcnt(6)
 v_mfma_f32_16x16x32_bf16 v[36:39], v[60:63], v[140:143], v[36:39]
 ds_read_b64_tr_b16 v[76:77], v8 offset:28672
 v_fmamk_f32 v100, v100, 0xbdd2d3e8, v15
 v_fmamk_f32 v101, v101, 0xbdd2d3e8, v15
 v_mfma_f32_16x16x32_bf16 v[44:47], v[60:63], v[204:207], v[44:47]
 ds_read_b64_tr_b16 v[78:79], v9 offset:28672
 s_add_u32 m0, s54, 90112
 s_xor_b32 s60, s58, 2944
 buffer_load_dwordx4 v5, s[24:27], s60 offen lds
 v_fmamk_f32 v102, v102, 0xbdd2d3e8, v15
 v_fmamk_f32 v103, v103, 0xbdd2d3e8, v15
 s_waitcnt vmcnt(8)
 s_cmp_lg_u32 s50, 1
 s_cbranch_scc1 L_ok_12
 s_waitcnt vmcnt(4)
 v_cmp_ne_u32 vcc, s53, v12
 s_nop 0
 s_and_b64 vcc, vcc, 0x1ffff
 s_cbranch_vccz L_ok_12
 s_mov_b32 s70, 50000
L_spin_13:
 s_sleep 1
 v_mov_b32 v12, 0
 s_mov_b64 exec, 0x1ffff
 buffer_atomic_or v12, v13, s[44:47], 0 offen sc0 sc1
 s_mov_b64 exec, -1
 s_waitcnt vmcnt(0)
 s_sub_u32 s70, s70, 1
 s_cbranch_scc1 L_ok_12
 v_cmp_ne_u32 vcc, s53, v12
 s_nop 0
 s_and_b64 vcc, vcc, 0x1ffff
 s_cbranch_vccnz L_spin_13
L_ok_12:
 s_waitcnt lgkmcnt(0)
 s_barrier
 v_mfma_f32_16x16x32_bf16 v[36:39], v[64:67], v[144:147], v[36:39]
 ds_read_b64_tr_b16 v[48:49], v8 offset:32768
 v_mul_f32 v96, v96, v32
 v_mul_f32 v97, v97, v33
 v_mfma_f32_16x16x32_bf16 v[44:47], v[64:67], v[208:211], v[44:47]
 ds_read_b64_tr_b16 v[50:51], v9 offset:32768
 s_xor_b32 s80, s68, 0
 buffer_load_dwordx4 v[128:131], v2, s[44:47], s80 offen sc1
 v_mul_f32 v98, v98, v34
 v_mul_f32 v99, v99, v35
 v_mfma_f32_16x16x32_bf16 v[36:39], v[68:71], v[148:151], v[36:39]
 ds_read_b64_tr_b16 v[52:53], v8 offset:36864
 v_mul_f32 v100, v100, v40
 v_mul_f32 v101, v101, v41
 v_mfma_f32_16x16x32_bf16 v[44:47], v[68:71], v[212:215], v[44:47]
 ds_read_b64_tr_b16 v[54:55], v9 offset:36864
 s_xor_b32 s80, s68, 1024
 buffer_load_dwordx4 v[192:195], v2, s[44:47], s80 offen sc1
 v_mul_f32 v102, v102, v42
 v_mul_f32 v103, v103, v43
 v_mfma_f32_16x16x32_bf16 v[36:39], v[72:75], v[152:155], v[36:39]
 ds_read_b64_tr_b16 v[56:57], v8 offset:40960
 v_exp_f32 v96, v96
 v_mfma_f32_16x16x32_bf16 v[44:47], v[72:75], v[216:219], v[44:47]
 ds_read_b64_tr_b16 v[58:59], v9 offset:40960
 s_xor_b32 s80, s68, 278528
 buffer_load_dwordx4 v[132:135], v2, s[44:47], s80 offen sc1
 v_exp_f32 v97, v97
 v_mfma_f32_16x16x32_bf16 v[36:39], v[76:79], v[156:159], v[36:39]
 ds_read_b64_tr_b16 v[60:61], v8 offset:45056
 v_exp_f32 v98, v98
 v_mfma_f32_16x16x32_bf16 v[44:47], v[76:79], v[220:223], v[44:47]
 ds_read_b64_tr_b16 v[62:63], v9 offset:45056
 v_exp_f32 v99, v99
 s_waitcnt lgkmcnt(6)
 v_mfma_f32_16x16x32_bf16 v[36:39], v[48:51], v[160:163], v[36:39]
 ds_read_b64_tr_b16 v[64:65], v8 offset:49152
 v_exp_f32 v100, v100
 v_mfma_f32_16x16x32_bf16 v[44:47], v[48:51], v[224:227], v[44:47]
 ds_read_b64_tr_b16 v[66:67], v9 offset:49152
 s_xor_b32 s80, s68, 279552
 buffer_load_dwordx4 v[196:199], v2, s[44:47], s80 offen sc1
 v_exp_f32 v101, v101
 s_waitcnt lgkmcnt(6)
 v_mfma_f32_16x16x32_bf16 v[36:39], v[52:55], v[164:167], v[36:39]
 ds_read_b64_tr_b16 v[68:69], v8 offset:53248
 v_exp_f32 v102, v102
 v_mfma_f32_16x16x32_bf16 v[44:47], v[52:55], v[228:231], v[44:47]
 ds_read_b64_tr_b16 v[70:71], v9 offset:53248
 s_xor_b32 s80, s68, 32768
 buffer_load_dwordx4 v[136:139], v2, s[44:47], s80 offen sc1
 v_exp_f32 v103, v103
 s_waitcnt lgkmcnt(6)
 v_mfma_f32_16x16x32_bf16 v[36:39], v[56:59], v[168:171], v[36:39]
 ds_read_b64_tr_b16 v[72:73], v8 offset:57344
 v_add_f32 v96, 1.0, v96
 v_add_f32 v97, 1.0, v97
 v_mfma_f32_16x16x32_bf16 v[44:47], v[56:59], v[232:235], v[44:47]
 ds_read_b64_tr_b16 v[74:75], v9 offset:57344
 s_xor_b32 s80, s68, 33792
 buffer_load_dwordx4 v[200:203], v2, s[44:47], s80 offen sc1
 v_add_f32 v98, 1.0, v98
 v_add_f32 v99, 1.0, v99
 s_waitcnt lgkmcnt(6)
 v_mfma_f32_16x16x32_bf16 v[36:39], v[60:63], v[172:175], v[36:39]
 ds_read_b64_tr_b16 v[76:77], v8 offset:61440
 v_add_f32 v100, 1.0, v100
 v_add_f32 v101, 1.0, v101
 v_mfma_f32_16x16x32_bf16 v[44:47], v[60:63], v[236:239], v[44:47]
 ds_read_b64_tr_b16 v[78:79], v9 offset:61440
 v_add_f32 v102, 1.0, v102
 v_add_f32 v103, 1.0, v103
 s_waitcnt vmcnt(10)
 s_waitcnt lgkmcnt(0)
 s_barrier
 v_and_b32 v8, 15, v1
 v_lshrrev_b32 v9, 4, v1
 s_lshl_b32 s62, s51, 2
 v_add_u32 v9, s62, v9
 v_lshrrev_b32 v10, 1, v8
 v_xor_b32 v9, v9, v10
 v_lshlrev_b32 v9, 4, v9
 v_lshl_add_u32 v8, v8, 7, v9
 s_lshl_b32 s62, s51, 12
 v_add_u32 v8, s62, v8
 v_xor_b32 v9, 4096, v8
 v_add_u32 v8, 0x10000, v8
 v_add_u32 v9, 0x10000, v9
 v_mfma_f32_16x16x32_bf16 v[36:39], v[64:67], v[176:179], v[36:39]
 ds_read_b128 v[48:51], v8 offset:32768
 v_rcp_f32 v96, v96
 v_mfma_f32_16x16x32_bf16 v[44:47], v[64:67], v[240:243], v[44:47]
 ds_read_b128 v[52:55], v8 offset:34816
 s_xor_b32 s80, s68, 311296
 buffer_load_dwordx4 v[140:143], v2, s[44:47], s80 offen sc1
 v_rcp_f32 v97, v97
 v_mfma_f32_16x16x32_bf16 v[36:39], v[68:71], v[180:183], v[36:39]
 ds_read_b128 v[56:59], v9 offset:32768
 v_rcp_f32 v98, v98
 v_mfma_f32_16x16x32_bf16 v[44:47], v[68:71], v[244:247], v[44:47]
 ds_read_b128 v[60:63], v9 offset:34816
 s_xor_b32 s80, s68, 312320
 buffer_load_dwordx4 v[204:207], v2, s[44:47], s80 offen sc1
 v_rcp_f32 v99, v99
 v_mfma_f32_16x16x32_bf16 v[36:39], v[72:75], v[184:187], v[36:39]
 v_rcp_f32 v100, v100
 v_mfma_f32_16x16x32_bf16 v[44:47], v[72:75], v[248:251], v[44:47]
 s_xor_b32 s80, s68, 65536
 buffer_load_dwordx4 v[144:147], v2, s[44:47], s80 offen sc1
 v_rcp_f32 v101, v101
 v_mfma_f32_16x16x32_bf16 v[36:39], v[76:79], v[188:191], v[36:39]
 v_rcp_f32 v102, v102
 v_mfma_f32_16x16x32_bf16 v[44:47], v[76:79], v[252:255], v[44:47]
 v_rcp_f32 v103, v103
 s_xor_b32 s80, s68, 66560
 buffer_load_dwordx4 v[208:211], v2, s[44:47], s80 offen sc1
 s_add_u32 m0, s54, 0
 s_xor_b32 s60, s58, 1024
 buffer_load_dwordx4 v5, s[24:27], s60 offen lds
 v_mul_f32 v32, v32, v96
 v_mul_f32 v33, v33, v97
 v_mul_f32 v34, v34, v98
 v_mul_f32 v35, v35, v99
 v_mul_f32 v40, v40, v100
 v_mul_f32 v41, v41, v101
 v_mul_f32 v42, v42, v102
 v_mul_f32 v43, v43, v103
 s_min_u32 s64, s48, 1
 s_andn2_b32 s64, s64, s51
 s_sub_u32 s62, s81, 60
 s_lshl_b32 s62, s62, 11
 s_add_u32 s62, s62, 20971520
 s_cmp_lg_u32 s51, 0
 s_cbranch_scc1 L_kv_14
 s_cmp_eq_u32 s64, 0
 s_cbranch_scc1 L_kv_15
 s_mov_b32 exec_lo, 0xff00ff00
 s_mov_b32 exec_hi, 0xff00ff00
 buffer_load_dwordx4 v[16:19], v2, s[44:47], s62 offen sc1
 s_mov_b32 exec_lo, 0
 s_mov_b32 exec_hi, -1
 buffer_load_dwordx4 v[20:23], v2, s[44:47], s62 offen offset:1024 sc1
 s_mov_b64 exec, -1
 s_branch L_kv_15
L_kv_14:
 ds_read_b128 v[16:19], v92
 ds_read_b128 v[20:23], v92 offset:1024
L_kv_15:
 s_waitcnt vmcnt(9)
 s_waitcnt lgkmcnt(2)
 v_mfma_f32_16x16x32_bf16 v[96:99], v[128:131], v[48:51], 0
 ds_read_b128 v[64:67], v8 offset:40960
 v_mul_f32 v24, v36, v36
 v_mul_f32 v25, v37, v37
 v_mfma_f32_16x16x32_bf16 v[100:103], v[192:195], v[48:51], 0
 ds_read_b128 v[68:71], v8 offset:43008
 s_add_u32 m0, s54, 8192
 s_xor_b32 s60, s58, 3200
 buffer_load_dwordx4 v5, s[24:27], s60 offen lds
 v_mul_f32 v26, v38, v38
 v_mul_f32 v27, v39, v39
 v_mfma_f32_16x16x32_bf16 v[104:107], v[128:131], v[52:55], 0
 ds_read_b128 v[72:75], v9 offset:40960
 v_mul_f32 v28, v44, v44
 v_mul_f32 v29, v45, v45
 v_mfma_f32_16x16x32_bf16 v[108:111], v[192:195], v[52:55], 0
 ds_read_b128 v[76:79], v9 offset:43008
 s_add_u32 m0, s54, 16384
 s_xor_b32 s60, s58, 1280
 buffer_load_dwordx4 v5, s[24:27], s60 offen lds
 v_mul_f32 v30, v46, v46
 v_mul_f32 v31, v47, v47
 s_waitcnt lgkmcnt(4)
 v_mfma_f32_16x16x32_bf16 v[112:115], v[128:131], v[56:59], 0
 v_fmamk_f32 v24, v24, 0xbdd2d3e8, v15
 v_fmamk_f32 v25, v25, 0xbdd2d3e8, v15
 v_mfma_f32_16x16x32_bf16 v[116:119], v[192:195], v[56:59], 0
 s_add_u32 m0, s54, 24576
 s_xor_b32 s60, s58, 3456
 buffer_load_dwordx4 v5, s[24:27], s60 offen lds
 v_fmamk_f32 v26, v26, 0xbdd2d3e8, v15
 v_fmamk_f32 v27, v27, 0xbdd2d3e8, v15
 v_mfma_f32_16x16x32_bf16 v[120:123], v[128:131], v[60:63], 0
 v_fmamk_f32 v28, v28, 0xbdd2d3e8, v15
 v_fmamk_f32 v29, v29, 0xbdd2d3e8, v15
 v_mfma_f32_16x16x32_bf16 v[124:127], v[192:195], v[60:63], 0
 v_fmamk_f32 v30, v30, 0xbdd2d3e8, v15
 v_fmamk_f32 v31, v31, 0xbdd2d3e8, v15
 s_waitcnt vmcnt(10)
 s_waitcnt lgkmcnt(2)
 v_mfma_f32_16x16x32_bf16 v[96:99], v[132:135], v[64:67], v[96:99]
 ds_read_b128 v[48:51], v8 offset:49152
 v_mul_f32 v24, v24, v36
 v_mul_f32 v25, v25, v37
 v_mfma_f32_16x16x32_bf16 v[100:103], v[196:199], v[64:67], v[100:103]
 ds_read_b128 v[52:55], v8 offset:51200
 v_mul_f32 v26, v26, v38
 v_mul_f32 v27, v27, v39
 v_mfma_f32_16x16x32_bf16 v[104:107], v[132:135], v[68:71], v[104:107]
 ds_read_b128 v[56:59], v9 offset:49152
 v_mul_f32 v28, v28, v44
 v_mul_f32 v29, v29, v45
 v_mfma_f32_16x16x32_bf16 v[108:111], v[196:199], v[68:71], v[108:111]
 ds_read_b128 v[60:63], v9 offset:51200
 s_xor_b32 s80, s68, 344064
 buffer_load_dwordx4 v[148:151], v2, s[44:47], s80 offen sc1
 v_mul_f32 v30, v30, v46
 v_mul_f32 v31, v31, v47
 s_waitcnt lgkmcnt(4)
 v_mfma_f32_16x16x32_bf16 v[112:115], v[132:135], v[72:75], v[112:115]
 v_exp_f32 v24, v24
 v_mfma_f32_16x16x32_bf16 v[116:119], v[196:199], v[72:75], v[116:119]
 v_exp_f32 v25, v25
 v_mfma_f32_16x16x32_bf16 v[120:123], v[132:135], v[76:79], v[120:123]
 v_exp_f32 v26, v26
 v_mfma_f32_16x16x32_bf16 v[124:127], v[196:199], v[76:79], v[124:127]
 s_xor_b32 s80, s68, 345088
 buffer_load_dwordx4 v[212:215], v2, s[44:47], s80 offen sc1
 v_exp_f32 v27, v27
 s_waitcnt vmcnt(10)
 s_waitcnt lgkmcnt(2)
 v_mfma_f32_16x16x32_bf16 v[96:99], v[136:139], v[48:51], v[96:99]
 ds_read_b128 v[64:67], v8 offset:57344
 v_exp_f32 v28, v28
 v_mfma_f32_16x16x32_bf16 v[100:103], v[200:203], v[48:51], v[100:103]
 ds_read_b128 v[68:71], v8 offset:59392
 s_xor_b32 s80, s68, 98304
 buffer_load_dwordx4 v[152:155], v2, s[44:47], s80 offen sc1
 v_exp_f32 v29, v29
 v_mfma_f32_16x16x32_bf16 v[104:107], v[136:139], v[52:55], v[104:107]
 ds_read_b128 v[72:75], v9 offset:57344
 v_exp_f32 v30, v30
 v_mfma_f32_16x16x32_bf16 v[108:111], v[200:203], v[52:55], v[108:111]
 ds_read_b128 v[76:79], v9 offset:59392
 s_xor_b32 s80, s68, 99328
 buffer_load_dwordx4 v[216:219], v2, s[44:47], s80 offen sc1
 v_exp_f32 v31, v31
 s_waitcnt lgkmcnt(4)
 v_mfma_f32_16x16x32_bf16 v[112:115], v[136:139], v[56:59], v[112:115]
 v_add_f32 v24, 1.0, v24
 v_add_f32 v25, 1.0, v25
 v_mfma_f32_16x16x32_bf16 v[116:119], v[200:203], v[56:59], v[116:119]
 s_xor_b32 s80, s68, 376832
 buffer_load_dwordx4 v[156:159], v2, s[44:47], s80 offen sc1
 v_add_f32 v26, 1.0, v26
 v_add_f32 v27, 1.0, v27
 v_mfma_f32_16x16x32_bf16 v[120:123], v[136:139], v[60:63], v[120:123]
 v_add_f32 v28, 1.0, v28
 v_add_f32 v29, 1.0, v29
 v_mfma_f32_16x16x32_bf16 v[124:127], v[200:203], v[60:63], v[124:127]
 v_add_f32 v30, 1.0, v30
 v_add_f32 v31, 1.0, v31
 s_waitcnt lgkmcnt(0)
 s_barrier
 s_waitcnt vmcnt(11)
 v_mfma_f32_16x16x32_bf16 v[96:99], v[140:143], v[64:67], v[96:99]
 ds_read_b128 v[48:51], v8 offset:0
 v_rcp_f32 v24, v24
 v_mfma_f32_16x16x32_bf16 v[100:103], v[204:207], v[64:67], v[100:103]
 ds_read_b128 v[52:55], v8 offset:2048
 v_rcp_f32 v25, v25
 v_mfma_f32_16x16x32_bf16 v[104:107], v[140:143], v[68:71], v[104:107]
 ds_read_b128 v[56:59], v9 offset:0
 v_rcp_f32 v26, v26
 v_mfma_f32_16x16x32_bf16 v[108:111], v[204:207], v[68:71], v[108:111]
 ds_read_b128 v[60:63], v9 offset:2048
 s_xor_b32 s80, s68, 377856
 buffer_load_dwordx4 v[220:223], v2, s[44:47], s80 offen sc1
 v_rcp_f32 v27, v27
 v_mfma_f32_16x16x32_bf16 v[112:115], v[140:143], v[72:75], v[112:115]
 v_rcp_f32 v28, v28
 v_mfma_f32_16x16x32_bf16 v[116:119], v[204:207], v[72:75], v[116:119]
 v_rcp_f32 v29, v29
 v_mfma_f32_16x16x32_bf16 v[120:123], v[140:143], v[76:79], v[120:123]
 v_rcp_f32 v30, v30
 v_mfma_f32_16x16x32_bf16 v[124:127], v[204:207], v[76:79], v[124:127]
 s_xor_b32 s80, s68, 131072
 buffer_load_dwordx4 v[160:163], v2, s[44:47], s80 offen sc1
 v_rcp_f32 v31, v31
 s_waitcnt vmcnt(11)
 s_waitcnt lgkmcnt(2)
 v_mfma_f32_16x16x32_bf16 v[96:99], v[144:147], v[48:51], v[96:99]
 ds_read_b128 v[64:67], v8 offset:8192
 v_mul_f32 v36, v36, v24
 v_mul_f32 v37, v37, v25
 v_mfma_f32_16x16x32_bf16 v[100:103], v[208:211], v[48:51], v[100:103]
 ds_read_b128 v[68:71], v8 offset:10240
 s_xor_b32 s80, s68, 132096
 buffer_load_dwordx4 v[224:227], v2, s[44:47], s80 offen sc1
 v_mul_f32 v38, v38, v26
 v_mul_f32 v39, v39, v27
 v_mfma_f32_16x16x32_bf16 v[104:107], v[144:147], v[52:55], v[104:107]
 ds_read_b128 v[72:75], v9 offset:8192
 v_mul_f32 v44, v44, v28
 v_mul_f32 v45, v45, v29
 v_mfma_f32_16x16x32_bf16 v[108:111], v[208:211], v[52:55], v[108:111]
 ds_read_b128 v[76:79], v9 offset:10240
 s_add_u32 m0, s54, 32768
 s_xor_b32 s60, s58, 1536
 buffer_load_dwordx4 v5, s[24:27], s60 offen lds
 v_mul_f32 v46, v46, v30
 v_mul_f32 v47, v47, v31
 s_waitcnt lgkmcnt(4)
 v_mfma_f32_16x16x32_bf16 v[112:115], v[144:147], v[56:59], v[112:115]
 v_mov_b32 v94, 0xf149f2ca
 s_or_b32 s62, s48, s51
 s_cselect_b32 s62, 0, 0xf149f2ca
 v_mov_b32 v95, s62
 v_mfma_f32_16x16x32_bf16 v[116:119], v[208:211], v[56:59], v[116:119]
 s_add_u32 m0, s54, 40960
 s_xor_b32 s60, s58, 3712
 buffer_load_dwordx4 v5, s[24:27], s60 offen lds
 s_mov_b32 vcc_lo, 0xf00fff00
 s_mov_b32 vcc_hi, 0xfff00ff
 v_cndmask_b32 v28, 0, v94, vcc
 s_mov_b32 vcc_lo, 0xe01ffe01
 s_mov_b32 vcc_hi, 0x1fff01ff
 v_cndmask_b32 v29, 0, v94, vcc
 v_mfma_f32_16x16x32_bf16 v[120:123], v[144:147], v[60:63], v[120:123]
 s_mov_b32 vcc_lo, 0xc03ffc03
 s_mov_b32 vcc_hi, 0x3fff03ff
 v_cndmask_b32 v30, 0, v94, vcc
 s_mov_b32 vcc_lo, 0x807ff807
 s_mov_b32 vcc_hi, 0x7fff07ff
 v_cndmask_b32 v31, 0, v94, vcc
 v_mfma_f32_16x16x32_bf16 v[124:127], v[208:211], v[60:63], v[124:127]
 s_mov_b32 vcc_lo, 0x0
 s_mov_b32 vcc_hi, 0xf0000
 v_cndmask_b32 v24, v94, v95, vcc
 s_mov_b32 vcc_lo, 0x0
 s_mov_b32 vcc_hi, 0x1f0001
 v_cndmask_b32 v25, v94, v95, vcc
 s_waitcnt vmcnt(8)
 s_waitcnt lgkmcnt(2)
 v_mfma_f32_16x16x32_bf16 v[96:99], v[148:151], v[64:67], v[96:99]
 ds_read_b128 v[48:51], v8 offset:16384
 s_mov_b32 vcc_lo, 0x0
 s_mov_b32 vcc_hi, 0x3f0003
 v_cndmask_b32 v26, v94, v95, vcc
 s_mov_b32 vcc_lo, 0x0
 s_mov_b32 vcc_hi, 0x7f0007
 v_cndmask_b32 v27, v94, v95, vcc
 v_mfma_f32_16x16x32_bf16 v[100:103], v[212:215], v[64:67], v[100:103]
 ds_read_b128 v[52:55], v8 offset:18432
 v_mfma_f32_16x16x16_bf16 v[28:31], v[80:81], v[88:89], v[28:31]
 v_mfma_f32_16x16x16_bf16 v[24:27], v[16:17], v[88:89], v[24:27]
 v_mfma_f32_16x16x32_bf16 v[104:107], v[148:151], v[68:71], v[104:107]
 ds_read_b128 v[56:59], v9 offset:16384
 v_mfma_f32_16x16x32_bf16 v[108:111], v[212:215], v[68:71], v[108:111]
 ds_read_b128 v[60:63], v9 offset:18432
 s_add_u32 m0, s54, 49152
 s_xor_b32 s60, s58, 1792
 buffer_load_dwordx4 v5, s[24:27], s60 offen lds
 s_waitcnt lgkmcnt(4)
 v_mfma_f32_16x16x32_bf16 v[112:115], v[148:151], v[72:75], v[112:115]
 v_mfma_f32_16x16x32_bf16 v[116:119], v[212:215], v[72:75], v[116:119]
 v_max3_f32 v93, v28, v29, v30
 v_max3_f32 v92, v24, v25, v26
 v_mfma_f32_16x16x32_bf16 v[120:123], v[148:151], v[76:79], v[120:123]
 v_max3_f32 v92, v92, v27, v31
 v_max_f32 v92, v92, v93
 v_mfma_f32_16x16x32_bf16 v[124:127], v[212:215], v[76:79], v[124:127]
 s_add_u32 m0, s54, 57344
 s_xor_b32 s60, s58, 3968
 buffer_load_dwordx4 v5, s[24:27], s60 offen lds
 v_mov_b32 v93, v92
 s_waitcnt vmcnt(8)
 s_waitcnt lgkmcnt(2)
 v_mfma_f32_16x16x32_bf16 v[96:99], v[152:155], v[48:51], v[96:99]
 ds_read_b128 v[64:67], v8 offset:24576
 v_permlane16_swap_b32 v92, v93
 v_max_f32 v92, v92, v93
 v_mfma_f32_16x16x32_bf16 v[100:103], v[216:219], v[48:51], v[100:103]
 ds_read_b128 v[68:71], v8 offset:26624
 s_xor_b32 s80, s68, 409600
 buffer_load_dwordx4 v[164:167], v2, s[44:47], s80 offen sc1
 v_mov_b32 v93, v92
 v_mfma_f32_16x16x32_bf16 v[104:107], v[152:155], v[52:55], v[104:107]
 ds_read_b128 v[72:75], v9 offset:24576
 v_permlane32_swap_b32 v92, v93
 v_max_f32 v92, v92, v93
 v_mfma_f32_16x16x32_bf16 v[108:111], v[216:219], v[52:55], v[108:111]
 ds_read_b128 v[76:79], v9 offset:26624
 s_xor_b32 s80, s68, 410624
 buffer_load_dwordx4 v[228:231], v2, s[44:47], s80 offen sc1
 v_mul_f32 v92, 0xbeb8aa3b, v92
 v_fmamk_f32 v24, v24, 0x3eb8aa3b, v92
 s_waitcnt lgkmcnt(4)
 v_mfma_f32_16x16x32_bf16 v[112:115], v[152:155], v[56:59], v[112:115]
 v_fmamk_f32 v25, v25, 0x3eb8aa3b, v92
 v_fmamk_f32 v26, v26, 0x3eb8aa3b, v92
 v_mfma_f32_16x16x32_bf16 v[116:119], v[216:219], v[56:59], v[116:119]
 s_xor_b32 s80, s68, 163840
 buffer_load_dwordx4 v[168:171], v2, s[44:47], s80 offen sc1
 v_fmamk_f32 v27, v27, 0x3eb8aa3b, v92
 v_fmamk_f32 v28, v28, 0x3eb8aa3b, v92
 v_mfma_f32_16x16x32_bf16 v[120:123], v[152:155], v[60:63], v[120:123]
 v_fmamk_f32 v29, v29, 0x3eb8aa3b, v92
 v_fmamk_f32 v30, v30, 0x3eb8aa3b, v92
 v_mfma_f32_16x16x32_bf16 v[124:127], v[216:219], v[60:63], v[124:127]
 v_fmamk_f32 v31, v31, 0x3eb8aa3b, v92
 v_exp_f32 v24, v24
 s_waitcnt lgkmcnt(0)
 s_barrier
 v_add_u32 v8, 0xffff0000, v8
 v_add_u32 v9, 0xffff0000, v9
 s_waitcnt vmcnt(9)
 v_mfma_f32_16x16x32_bf16 v[96:99], v[156:159], v[64:67], v[96:99]
 ds_read_b128 v[48:51], v8 offset:0
 v_exp_f32 v25, v25
 v_mfma_f32_16x16x32_bf16 v[100:103], v[220:223], v[64:67], v[100:103]
 ds_read_b128 v[52:55], v8 offset:2048
 v_exp_f32 v26, v26
 v_mfma_f32_16x16x32_bf16 v[104:107], v[156:159], v[68:71], v[104:107]
 ds_read_b128 v[56:59], v9 offset:0
 v_exp_f32 v27, v27
 v_mfma_f32_16x16x32_bf16 v[108:111], v[220:223], v[68:71], v[108:111]
 ds_read_b128 v[60:63], v9 offset:2048
 s_xor_b32 s80, s68, 164864
 buffer_load_dwordx4 v[232:235], v2, s[44:47], s80 offen sc1
 v_exp_f32 v28, v28
 v_mfma_f32_16x16x32_bf16 v[112:115], v[156:159], v[72:75], v[112:115]
 v_exp_f32 v29, v29
 v_mfma_f32_16x16x32_bf16 v[116:119], v[220:223], v[72:75], v[116:119]
 v_exp_f32 v30, v30
 v_mfma_f32_16x16x32_bf16 v[120:123], v[156:159], v[76:79], v[120:123]
 v_exp_f32 v31, v31
 v_mfma_f32_16x16x32_bf16 v[124:127], v[220:223], v[76:79], v[124:127]
 s_xor_b32 s80, s68, 442368
 buffer_load_dwordx4 v[172:175], v2, s[44:47], s80 offen sc1
 v_add_f32 v92, v24, v25
 s_waitcnt vmcnt(9)
 s_waitcnt lgkmcnt(2)
 v_mfma_f32_16x16x32_bf16 v[96:99], v[160:163], v[48:51], v[96:99]
 ds_read_b128 v[64:67], v8 offset:8192
 v_add_f32 v93, v26, v27
 v_add_f32 v92, v92, v28
 v_mfma_f32_16x16x32_bf16 v[100:103], v[224:227], v[48:51], v[100:103]
 ds_read_b128 v[68:71], v8 offset:10240
 s_xor_b32 s80, s68, 443392
 buffer_load_dwordx4 v[236:239], v2, s[44:47], s80 offen sc1
 v_add_f32 v93, v93, v29
 v_add_f32 v92, v92, v30
 v_mfma_f32_16x16x32_bf16 v[104:107], v[160:163], v[52:55], v[104:107]
 ds_read_b128 v[72:75], v9 offset:8192
 v_add_f32 v93, v93, v31
 v_cvt_pk_bf16_f32 v24, v24, v25
 v_mfma_f32_16x16x32_bf16 v[108:111], v[224:227], v[52:55], v[108:111]
 ds_read_b128 v[76:79], v9 offset:10240
 s_xor_b32 s80, s68, 196608
 buffer_load_dwordx4 v[176:179], v2, s[44:47], s80 offen sc1
 v_cvt_pk_bf16_f32 v25, v26, v27
 v_cvt_pk_bf16_f32 v26, v28, v29
 s_waitcnt lgkmcnt(4)
 v_mfma_f32_16x16x32_bf16 v[112:115], v[160:163], v[56:59], v[112:115]
 v_cvt_pk_bf16_f32 v27, v30, v31
 v_add_f32 v92, v92, v93
 v_mfma_f32_16x16x32_bf16 v[116:119], v[224:227], v[56:59], v[116:119]
 s_xor_b32 s80, s68, 197632
 buffer_load_dwordx4 v[240:243], v2, s[44:47], s80 offen sc1
 v_mfma_f32_16x16x16_bf16 v[28:31], v[20:21], v[24:25], 0
 v_mfma_f32_16x16x16_bf16 v[28:31], v[84:85], v[26:27], v[28:31]
 v_mfma_f32_16x16x32_bf16 v[120:123], v[160:163], v[60:63], v[120:123]
 v_mov_b32 v93, v92
 v_mfma_f32_16x16x32_bf16 v[124:127], v[224:227], v[60:63], v[124:127]
 s_nop 0
 v_permlane16_swap_b32 v92, v93
 v_add_f32 v92, v92, v93
 s_waitcnt vmcnt(6)
 s_waitcnt lgkmcnt(2)
 v_mfma_f32_16x16x32_bf16 v[96:99], v[164:167], v[64:67], v[96:99]
 ds_read_b128 v[48:51], v8 offset:16384
 v_mov_b32 v93, v92
 v_mfma_f32_16x16x32_bf16 v[100:103], v[228:231], v[64:67], v[100:103]
 ds_read_b128 v[52:55], v8 offset:18432
 v_permlane32_swap_b32 v92, v93
 v_add_f32 v92, v92, v93
 v_mfma_f32_16x16x32_bf16 v[104:107], v[164:167], v[68:71], v[104:107]
 ds_read_b128 v[56:59], v9 offset:16384
 v_rcp_f32 v92, v92
 v_mfma_f32_16x16x32_bf16 v[108:111], v[228:231], v[68:71], v[108:111]
 ds_read_b128 v[60:63], v9 offset:18432
 s_add_u32 m0, s54, 98304
 s_xor_b32 s60, s69, 0
 buffer_load_dwordx4 v5, s[24:27], s60 offen lds
 v_mul_f32 v28, v28, v92
 v_mul_f32 v29, v29, v92
 s_waitcnt lgkmcnt(4)
 v_mfma_f32_16x16x32_bf16 v[112:115], v[164:167], v[72:75], v[112:115]
 v_mul_f32 v30, v30, v92
 v_mul_f32 v31, v31, v92
 v_mfma_f32_16x16x32_bf16 v[116:119], v[228:231], v[72:75], v[116:119]
 v_cvt_pk_bf16_f32 v88, v28, v29
 v_cvt_pk_bf16_f32 v89, v30, v31
 v_mfma_f32_16x16x32_bf16 v[120:123], v[164:167], v[76:79], v[120:123]
 s_mov_b32 vcc_lo, 0xf00fff00
 s_mov_b32 vcc_hi, 0xfff00ff
 v_cndmask_b32 v28, 0, v94, vcc
 s_mov_b32 vcc_lo, 0xe01ffe01
 s_mov_b32 vcc_hi, 0x1fff01ff
 v_cndmask_b32 v29, 0, v94, vcc
 v_mfma_f32_16x16x32_bf16 v[124:127], v[228:231], v[76:79], v[124:127]
 s_add_u32 m0, s54, 106496
 s_xor_b32 s60, s69, 2176
 buffer_load_dwordx4 v5, s[24:27], s60 offen lds
 s_mov_b32 vcc_lo, 0xc03ffc03
 s_mov_b32 vcc_hi, 0x3fff03ff
 v_cndmask_b32 v30, 0, v94, vcc
 s_mov_b32 vcc_lo, 0x807ff807
 s_mov_b32 vcc_hi, 0x7fff07ff
 v_cndmask_b32 v31, 0, v94, vcc
 s_waitcnt vmcnt(6)
 s_waitcnt lgkmcnt(2)
 v_mfma_f32_16x16x32_bf16 v[96:99], v[168:171], v[48:51], v[96:99]
 ds_read_b128 v[64:67], v8 offset:24576
 s_mov_b32 vcc_lo, 0x0
 s_mov_b32 vcc_hi, 0xf0000
 v_cndmask_b32 v24, v94, v95, vcc
 s_mov_b32 vcc_lo, 0x0
 s_mov_b32 vcc_hi, 0x1f0001
 v_cndmask_b32 v25, v94, v95, vcc
 v_mfma_f32_16x16x32_bf16 v[100:103], v[232:235], v[48:51], v[100:103]
 ds_read_b128 v[68:71], v8 offset:26624
 s_add_u32 m0, s54, 114688
 s_xor_b32 s60, s69, 256
 buffer_load_dwordx4 v5, s[24:27], s60 offen lds
 s_mov_b32 vcc_lo, 0x0
 s_mov_b32 vcc_hi, 0x3f0003
 v_cndmask_b32 v26, v94, v95, vcc
 s_mov_b32 vcc_lo, 0x0
 s_mov_b32 vcc_hi, 0x7f0007
 v_cndmask_b32 v27, v94, v95, vcc
 v_mfma_f32_16x16x32_bf16 v[104:107], v[168:171], v[52:55], v[104:107]
 ds_read_b128 v[72:75], v9 offset:24576
 v_mfma_f32_16x16x16_bf16 v[28:31], v[82:83], v[90:91], v[28:31]
 v_mfma_f32_16x16x16_bf16 v[24:27], v[18:19], v[90:91], v[24:27]
 v_mfma_f32_16x16x32_bf16 v[108:111], v[232:235], v[52:55], v[108:111]
 ds_read_b128 v[76:79], v9 offset:26624
 s_add_u32 m0, s54, 122880
 s_xor_b32 s60, s69, 2432
 buffer_load_dwordx4 v5, s[24:27], s60 offen lds
 s_waitcnt lgkmcnt(4)
 v_mfma_f32_16x16x32_bf16 v[112:115], v[168:171], v[56:59], v[112:115]
 v_mfma_f32_16x16x32_bf16 v[116:119], v[232:235], v[56:59], v[116:119]
 s_xor_b32 s80, s68, 475136
 buffer_load_dwordx4 v[180:183], v2, s[44:47], s80 offen sc1
 v_mfma_f32_16x16x32_bf16 v[120:123], v[168:171], v[60:63], v[120:123]
 v_max3_f32 v93, v28, v29, v30
 v_max3_f32 v92, v24, v25, v26
 v_mfma_f32_16x16x32_bf16 v[124:127], v[232:235], v[60:63], v[124:127]
 v_max3_f32 v92, v92, v27, v31
 v_max_f32 v92, v92, v93
 s_waitcnt lgkmcnt(0)
 s_barrier
 s_waitcnt vmcnt(7)
 v_mfma_f32_16x16x32_bf16 v[96:99], v[172:175], v[64:67], v[96:99]
 ds_read_b128 v[48:51], v8 offset:32768
 v_mov_b32 v93, v92
 v_mfma_f32_16x16x32_bf16 v[100:103], v[236:239], v[64:67], v[100:103]
 ds_read_b128 v[52:55], v8 offset:34816
 v_permlane16_swap_b32 v92, v93
 v_max_f32 v92, v92, v93
 v_mfma_f32_16x16x32_bf16 v[104:107], v[172:175], v[68:71], v[104:107]
 ds_read_b128 v[56:59], v9 offset:32768
 v_mov_b32 v93, v92
 v_mfma_f32_16x16x32_bf16 v[108:111], v[236:239], v[68:71], v[108:111]
 ds_read_b128 v[60:63], v9 offset:34816
 s_xor_b32 s80, s68, 476160
 buffer_load_dwordx4 v[244:247], v2, s[44:47], s80 offen sc1
 v_permlane32_swap_b32 v92, v93
 v_max_f32 v92, v92, v93
 v_mfma_f32_16x16x32_bf16 v[112:115], v[172:175], v[72:75], v[112:115]
 v_mul_f32 v92, 0xbeb8aa3b, v92
 v_fmamk_f32 v24, v24, 0x3eb8aa3b, v92
 v_mfma_f32_16x16x32_bf16 v[116:119], v[236:239], v[72:75], v[116:119]
 v_fmamk_f32 v25, v25, 0x3eb8aa3b, v92
 v_fmamk_f32 v26, v26, 0x3eb8aa3b, v92
 v_mfma_f32_16x16x32_bf16 v[120:123], v[172:175], v[76:79], v[120:123]
 v_fmamk_f32 v27, v27, 0x3eb8aa3b, v92
 v_fmamk_f32 v28, v28, 0x3eb8aa3b, v92
 v_mfma_f32_16x16x32_bf16 v[124:127], v[236:239], v[76:79], v[124:127]
 s_xor_b32 s80, s68, 229376
 buffer_load_dwordx4 v[184:187], v2, s[44:47], s80 offen sc1
 v_fmamk_f32 v29, v29, 0x3eb8aa3b, v92
 v_fmamk_f32 v30, v30, 0x3eb8aa3b, v92
 s_waitcnt vmcnt(7)
 s_waitcnt lgkmcnt(2)
 v_mfma_f32_16x16x32_bf16 v[96:99], v[176:179], v[48:51], v[96:99]
 ds_read_b128 v[64:67], v8 offset:40960
 v_fmamk_f32 v31, v31, 0x3eb8aa3b, v92
 v_exp_f32 v24, v24
 v_mfma_f32_16x16x32_bf16 v[100:103], v[240:243], v[48:51], v[100:103]
 ds_read_b128 v[68:71], v8 offset:43008
 s_xor_b32 s80, s68, 230400
 buffer_load_dwordx4 v[248:251], v2, s[44:47], s80 offen sc1
 v_exp_f32 v25, v25
 v_mfma_f32_16x16x32_bf16 v[104:107], v[176:179], v[52:55], v[104:107]
 ds_read_b128 v[72:75], v9 offset:40960
 v_exp_f32 v26, v26
 v_mfma_f32_16x16x32_bf16 v[108:111], v[240:243], v[52:55], v[108:111]
 ds_read_b128 v[76:79], v9 offset:43008
 s_xor_b32 s80, s68, 507904
 buffer_load_dwordx4 v[188:191], v2, s[44:47], s80 offen sc1
 v_exp_f32 v27, v27
 s_waitcnt lgkmcnt(4)
 v_mfma_f32_16x16x32_bf16 v[112:115], v[176:179], v[56:59], v[112:115]
 v_exp_f32 v28, v28
 v_mfma_f32_16x16x32_bf16 v[116:119], v[240:243], v[56:59], v[116:119]
 s_xor_b32 s80, s68, 508928
 buffer_load_dwordx4 v[252:255], v2, s[44:47], s80 offen sc1
 v_exp_f32 v29, v29
 v_mfma_f32_16x16x32_bf16 v[120:123], v[176:179], v[60:63], v[120:123]
 v_exp_f32 v30, v30
 v_mfma_f32_16x16x32_bf16 v[124:127], v[240:243], v[60:63], v[124:127]
 v_exp_f32 v31, v31
 s_waitcnt vmcnt(4)
 s_waitcnt lgkmcnt(2)
 v_mfma_f32_16x16x32_bf16 v[96:99], v[180:183], v[64:67], v[96:99]
 ds_read_b128 v[48:51], v8 offset:49152
 v_add_f32 v92, v24, v25
 v_mfma_f32_16x16x32_bf16 v[100:103], v[244:247], v[64:67], v[100:103]
 ds_read_b128 v[52:55], v8 offset:51200
 v_add_f32 v93, v26, v27
 v_add_f32 v92, v92, v28
 v_mfma_f32_16x16x32_bf16 v[104:107], v[180:183], v[68:71], v[104:107]
 ds_read_b128 v[56:59], v9 offset:49152
 v_add_f32 v93, v93, v29
 v_add_f32 v92, v92, v30
 v_mfma_f32_16x16x32_bf16 v[108:111], v[244:247], v[68:71], v[108:111]
 ds_read_b128 v[60:63], v9 offset:51200
 s_add_u32 m0, s54, 65536
 s_xor_b32 s60, s69, 512
 buffer_load_dwordx4 v5, s[24:27], s60 offen lds
 v_add_f32 v93, v93, v31
 v_cvt_pk_bf16_f32 v24, v24, v25
 s_waitcnt lgkmcnt(4)
 v_mfma_f32_16x16x32_bf16 v[112:115], v[180:183], v[72:75], v[112:115]
 v_cvt_pk_bf16_f32 v25, v26, v27
 v_cvt_pk_bf16_f32 v26, v28, v29
 v_mfma_f32_16x16x32_bf16 v[116:119], v[244:247], v[72:75], v[116:119]
 v_cvt_pk_bf16_f32 v27, v30, v31
 v_add_f32 v92, v92, v93
 v_mfma_f32_16x16x32_bf16 v[120:123], v[180:183], v[76:79], v[120:123]
 v_mfma_f32_16x16x16_bf16 v[28:31], v[22:23], v[24:25], 0
 v_mfma_f32_16x16x16_bf16 v[28:31], v[86:87], v[26:27], v[28:31]
 v_mfma_f32_16x16x32_bf16 v[124:127], v[244:247], v[76:79], v[124:127]
 s_add_u32 m0, s54, 73728
 s_xor_b32 s60, s69, 2688
 buffer_load_dwordx4 v5, s[24:27], s60 offen lds
 v_mov_b32 v93, v92
 s_waitcnt vmcnt(4)
 s_waitcnt lgkmcnt(2)
 v_mfma_f32_16x16x32_bf16 v[96:99], v[184:187], v[48:51], v[96:99]
 ds_read_b128 v[64:67], v8 offset:57344
 v_permlane16_swap_b32 v92, v93
 v_add_f32 v92, v92, v93
 v_mfma_f32_16x16x32_bf16 v[100:103], v[248:251], v[48:51], v[100:103]
 ds_read_b128 v[68:71], v8 offset:59392
 s_add_u32 m0, s54, 81920
 s_xor_b32 s60, s69, 768
 buffer_load_dwordx4 v5, s[24:27], s60 offen lds
 v_mov_b32 v93, v92
 v_mfma_f32_16x16x32_bf16 v[104:107], v[184:187], v[52:55], v[104:107]
 ds_read_b128 v[72:75], v9 offset:57344
 v_permlane32_swap_b32 v92, v93
 v_add_f32 v92, v92, v93
 v_mfma_f32_16x16x32_bf16 v[108:111], v[248:251], v[52:55], v[108:111]
 ds_read_b128 v[76:79], v9 offset:59392
 s_add_u32 m0, s54, 90112
 s_xor_b32 s60, s69, 2944
 buffer_load_dwordx4 v5, s[24:27], s60 offen lds
 v_rcp_f32 v92, v92
 s_waitcnt lgkmcnt(4)
 v_mfma_f32_16x16x32_bf16 v[112:115], v[184:187], v[56:59], v[112:115]
 v_mul_f32 v28, v28, v92
 v_mul_f32 v29, v29, v92
 v_mfma_f32_16x16x32_bf16 v[116:119], v[248:251], v[56:59], v[116:119]
 s_add_u32 m0, s54, 0
 s_xor_b32 s60, s69, 1024
 buffer_load_dwordx4 v5, s[24:27], s60 offen lds
 v_mul_f32 v30, v30, v92
 v_mul_f32 v31, v31, v92
 v_mfma_f32_16x16x32_bf16 v[120:123], v[184:187], v[60:63], v[120:123]
 v_cvt_pk_bf16_f32 v90, v28, v29
 v_cvt_pk_bf16_f32 v91, v30, v31
 v_mfma_f32_16x16x32_bf16 v[124:127], v[248:251], v[60:63], v[124:127]
 v_and_b32 v92, 0xf0, v2
 v_lshrrev_b32 v93, 5, v1
 s_waitcnt lgkmcnt(0)
 s_barrier
 v_add_u32 v8, 0x10000, v8
 v_add_u32 v9, 0x10000, v9
 s_waitcnt vmcnt(5)
 v_mfma_f32_16x16x32_bf16 v[96:99], v[188:191], v[64:67], v[96:99]
 ds_read_b128 v[48:51], v8 offset:32768
 v_lshl_add_u32 v92, v93, 8, v92
 v_bfe_u32 v93, v1, 4, 1
 v_mfma_f32_16x16x32_bf16 v[100:103], v[252:255], v[64:67], v[100:103]
 ds_read_b128 v[52:55], v8 offset:34816
 v_lshl_add_u32 v92, v93, 14, v92
 v_permlane16_swap_b32 v88, v90
 v_mfma_f32_16x16x32_bf16 v[104:107], v[188:191], v[68:71], v[104:107]
 ds_read_b128 v[56:59], v9 offset:32768
 v_permlane16_swap_b32 v89, v91
 s_lshl_b32 s62, s48, 1
 s_add_u32 s62, s62, s51
 s_lshl_b32 s62, s62, 4
 s_add_u32 s62, s62, s65
 s_lshl_b32 s62, s62, 2
 s_add_u32 s62, s62, s52
 s_lshl_b32 s62, s62, 9
 s_add_u32 s62, s62, 4194304
 buffer_store_dwordx4 v[88:91], v92, s[44:47], s62 offen sc1
 s_nop 1
 v_mfma_f32_16x16x32_bf16 v[108:111], v[252:255], v[68:71], v[108:111]
 ds_read_b128 v[60:63], v9 offset:34816
 s_add_u32 m0, s54, 8192
 s_xor_b32 s60, s69, 3200
 buffer_load_dwordx4 v5, s[24:27], s60 offen lds
 v_mfma_f32_16x16x32_bf16 v[112:115], v[188:191], v[72:75], v[112:115]
 v_mfma_f32_16x16x32_bf16 v[116:119], v[252:255], v[72:75], v[116:119]
 v_mfma_f32_16x16x32_bf16 v[120:123], v[188:191], v[76:79], v[120:123]
 v_mfma_f32_16x16x32_bf16 v[124:127], v[252:255], v[76:79], v[124:127]
 s_add_u32 m0, s54, 16384
 s_xor_b32 s60, s69, 1280
 buffer_load_dwordx4 v5, s[24:27], s60 offen lds
 s_waitcnt lgkmcnt(2)
 v_mfma_f32_16x16x32_bf16 v[16:19], v[128:131], v[48:51], 0
 ds_read_b128 v[64:67], v8 offset:40960
 s_lshl_b32 s62, s50, 12
 s_add_u32 s62, s62, 131072
 v_add_u32 v10, s62, v2
 v_xor_b32 v11, 0x4000, v10
 s_nop 4
 ds_write_b128 v10, v[112:115] offset:0
 v_mfma_f32_16x16x32_bf16 v[20:23], v[192:195], v[48:51], 0
 ds_read_b128 v[68:71], v8 offset:43008
 s_add_u32 m0, s54, 24576
 s_xor_b32 s60, s69, 3456
 buffer_load_dwordx4 v5, s[24:27], s60 offen lds
 ds_write_b128 v10, v[116:119] offset:1024
 v_mfma_f32_16x16x32_bf16 v[24:27], v[128:131], v[52:55], 0
 ds_read_b128 v[72:75], v9 offset:40960
 v_mfma_f32_16x16x32_bf16 v[28:31], v[192:195], v[52:55], 0
 ds_read_b128 v[76:79], v9 offset:43008
 s_add_u32 m0, s54, 32768
 s_xor_b32 s60, s69, 1536
 buffer_load_dwordx4 v5, s[24:27], s60 offen lds
 ds_write_b128 v10, v[120:123] offset:2048
 s_waitcnt lgkmcnt(7)
 v_mfma_f32_16x16x32_bf16 v[80:83], v[128:131], v[56:59], 0
 ds_write_b128 v10, v[124:127] offset:3072
 v_mfma_f32_16x16x32_bf16 v[84:87], v[192:195], v[56:59], 0
 s_add_u32 m0, s54, 40960
 s_xor_b32 s60, s69, 3712
 buffer_load_dwordx4 v5, s[24:27], s60 offen lds
 v_mfma_f32_16x16x32_bf16 v[88:91], v[128:131], v[60:63], 0
 v_mfma_f32_16x16x32_bf16 v[92:95], v[192:195], v[60:63], 0
 s_waitcnt lgkmcnt(5)
 v_mfma_f32_16x16x32_bf16 v[16:19], v[132:135], v[64:67], v[16:19]
 ds_read_b128 v[48:51], v8 offset:49152
 s_waitcnt lgkmcnt(0)
 s_barrier
 ds_read_b128 v[112:115], v11 offset:0
 ds_read_b128 v[116:119], v11 offset:1024
 v_mfma_f32_16x16x32_bf16 v[20:23], v[196:199], v[64:67], v[20:23]
 ds_read_b128 v[52:55], v8 offset:51200
 ds_read_b128 v[120:123], v11 offset:2048
 ds_read_b128 v[124:127], v11 offset:3072
 v_mfma_f32_16x16x32_bf16 v[24:27], v[132:135], v[68:71], v[24:27]
 ds_read_b128 v[56:59], v9 offset:49152
 s_xor_b32 s80, s81, 64
 s_lshl_b32 s80, s80, 11
 s_add_u32 s80, s80, 16777216
 v_mfma_f32_16x16x32_bf16 v[28:31], v[196:199], v[68:71], v[28:31]
 ds_read_b128 v[60:63], v9 offset:51200
 v_mfma_f32_16x16x32_bf16 v[80:83], v[132:135], v[72:75], v[80:83]
 s_waitcnt lgkmcnt(2)
 v_add_f32 v96, v96, v112
 v_add_f32 v97, v97, v113
 v_mfma_f32_16x16x32_bf16 v[84:87], v[196:199], v[72:75], v[84:87]
 v_add_f32 v98, v98, v114
 v_add_f32 v99, v99, v115
 v_mfma_f32_16x16x32_bf16 v[88:91], v[132:135], v[76:79], v[88:91]
 v_add_f32 v100, v100, v116
 v_add_f32 v101, v101, v117
 v_mfma_f32_16x16x32_bf16 v[92:95], v[196:199], v[76:79], v[92:95]
 s_add_u32 m0, s54, 49152
 s_xor_b32 s60, s69, 1792
 buffer_load_dwordx4 v5, s[24:27], s60 offen lds
 v_add_f32 v102, v102, v118
 v_add_f32 v103, v103, v119
 v_mfma_f32_16x16x32_bf16 v[16:19], v[136:139], v[48:51], v[16:19]
 ds_read_b128 v[64:67], v8 offset:57344
 v_cvt_pk_bf16_f32 v96, v96, v97
 v_cvt_pk_bf16_f32 v97, v98, v99
 v_mfma_f32_16x16x32_bf16 v[20:23], v[200:203], v[48:51], v[20:23]
 ds_read_b128 v[68:71], v8 offset:59392
 v_cvt_pk_bf16_f32 v98, v100, v101
 v_cvt_pk_bf16_f32 v99, v102, v103
 v_mfma_f32_16x16x32_bf16 v[24:27], v[136:139], v[52:55], v[24:27]
 ds_read_b128 v[72:75], v9 offset:57344
 buffer_store_dwordx4 v[96:99], v2, s[44:47], s80 offen offset:0 sc1
 v_add_f32 v104, v104, v120
 v_mfma_f32_16x16x32_bf16 v[28:31], v[200:203], v[52:55], v[28:31]
 ds_read_b128 v[76:79], v9 offset:59392
 v_add_f32 v105, v105, v121
 v_add_f32 v106, v106, v122
 s_waitcnt lgkmcnt(4)
 v_mfma_f32_16x16x32_bf16 v[80:83], v[136:139], v[56:59], v[80:83]
 v_add_f32 v107, v107, v123
 v_add_f32 v108, v108, v124
 v_mfma_f32_16x16x32_bf16 v[84:87], v[200:203], v[56:59], v[84:87]
 v_add_f32 v109, v109, v125
 v_add_f32 v110, v110, v126
 v_mfma_f32_16x16x32_bf16 v[88:91], v[136:139], v[60:63], v[88:91]
 v_add_f32 v111, v111, v127
 v_cvt_pk_bf16_f32 v104, v104, v105
 v_mfma_f32_16x16x32_bf16 v[92:95], v[200:203], v[60:63], v[92:95]
 v_cvt_pk_bf16_f32 v105, v106, v107
 v_cvt_pk_bf16_f32 v106, v108, v109
 s_waitcnt vmcnt(9)
 s_waitcnt lgkmcnt(0)
 s_barrier
 v_mfma_f32_16x16x32_bf16 v[16:19], v[140:143], v[64:67], v[16:19]
 ds_read_b128 v[48:51], v8 offset:0
 v_cvt_pk_bf16_f32 v107, v110, v111
 buffer_store_dwordx4 v[104:107], v2, s[44:47], s80 offen offset:1024 sc1
 v_mfma_f32_16x16x32_bf16 v[20:23], v[204:207], v[64:67], v[20:23]
 ds_read_b128 v[52:55], v8 offset:2048
 v_lshrrev_b32 v112, 4, v1
 v_and_b32 v114, 3, v1
 v_mfma_f32_16x16x32_bf16 v[24:27], v[140:143], v[68:71], v[24:27]
 ds_read_b128 v[56:59], v9 offset:0
 v_bfe_u32 v113, v1, 2, 2
 v_lshl_add_u32 v3, v112, 3, v113
 v_mfma_f32_16x16x32_bf16 v[28:31], v[204:207], v[68:71], v[28:31]
 ds_read_b128 v[60:63], v9 offset:2048
 v_lshlrev_b32 v3, 7, v3
 v_lshl_add_u32 v3, v114, 3, v3
 v_mfma_f32_16x16x32_bf16 v[80:83], v[140:143], v[72:75], v[80:83]
 v_lshrrev_b32 v4, 2, v1
 v_lshlrev_b32 v4, 7, v4
 v_mfma_f32_16x16x32_bf16 v[84:87], v[204:207], v[72:75], v[84:87]
 v_lshl_add_u32 v4, v114, 3, v4
 v_lshrrev_b32 v113, 1, v113
 v_mfma_f32_16x16x32_bf16 v[88:91], v[140:143], v[76:79], v[88:91]
 v_xor_b32 v114, s51, v112
 v_and_b32 v115, 1, v114
 v_mfma_f32_16x16x32_bf16 v[92:95], v[204:207], v[76:79], v[92:95]
 s_add_u32 m0, s54, 57344
 s_xor_b32 s60, s69, 3968
 buffer_load_dwordx4 v5, s[24:27], s60 offen lds
 v_lshl_add_u32 v115, v115, 1, v113
 v_lshl_add_u32 v3, v115, 5, v3
 s_waitcnt lgkmcnt(2)
 v_mfma_f32_16x16x32_bf16 v[16:19], v[144:147], v[48:51], v[16:19]
 ds_read_b128 v[64:67], v8 offset:8192
 v_lshrrev_b32 v112, 1, v112
 v_xor_b32 v114, v114, v112
 v_mfma_f32_16x16x32_bf16 v[20:23], v[208:211], v[48:51], v[20:23]
 ds_read_b128 v[68:71], v8 offset:10240
 v_and_b32 v114, 1, v114
 v_lshl_add_u32 v114, v114, 1, v113
 v_mfma_f32_16x16x32_bf16 v[24:27], v[144:147], v[52:55], v[24:27]
 ds_read_b128 v[72:75], v9 offset:8192
 v_lshl_add_u32 v4, v114, 5, v4
 s_lshl_b32 s63, s51, 12
 v_add_u32 v3, s63, v3
 v_mfma_f32_16x16x32_bf16 v[28:31], v[208:211], v[52:55], v[28:31]
 ds_read_b128 v[76:79], v9 offset:10240
 s_add_u32 m0, s54, 98304
 s_add_u32 s60, s59, 0
 buffer_load_dwordx4 v6, s[16:19], s60 offen lds
 s_lshl_b32 s63, s51, 11
 v_add_u32 v4, s63, v4
 s_waitcnt lgkmcnt(4)
 v_mfma_f32_16x16x32_bf16 v[80:83], v[144:147], v[56:59], v[80:83]
 v_mfma_f32_16x16x32_bf16 v[84:87], v[208:211], v[56:59], v[84:87]
 v_mfma_f32_16x16x32_bf16 v[88:91], v[144:147], v[60:63], v[88:91]
 v_mfma_f32_16x16x32_bf16 v[92:95], v[208:211], v[60:63], v[92:95]
 s_add_u32 m0, s54, 106496
 s_add_u32 s60, s59, 65536
 buffer_load_dwordx4 v6, s[16:19], s60 offen lds
 s_waitcnt lgkmcnt(2)
 v_mfma_f32_16x16x32_bf16 v[16:19], v[148:151], v[64:67], v[16:19]
 ds_read_b128 v[48:51], v8 offset:16384
 v_mfma_f32_16x16x32_bf16 v[20:23], v[212:215], v[64:67], v[20:23]
 ds_read_b128 v[52:55], v8 offset:18432
 v_mfma_f32_16x16x32_bf16 v[24:27], v[148:151], v[68:71], v[24:27]
 ds_read_b128 v[56:59], v9 offset:16384
 v_mfma_f32_16x16x32_bf16 v[28:31], v[212:215], v[68:71], v[28:31]
 ds_read_b128 v[60:63], v9 offset:18432
 s_add_u32 m0, s54, 114688
 s_add_u32 s60, s59, 131072
 buffer_load_dwordx4 v6, s[16:19], s60 offen lds
 s_waitcnt lgkmcnt(4)
 v_mfma_f32_16x16x32_bf16 v[80:83], v[148:151], v[72:75], v[80:83]
 v_mfma_f32_16x16x32_bf16 v[84:87], v[212:215], v[72:75], v[84:87]
 v_mfma_f32_16x16x32_bf16 v[88:91], v[148:151], v[76:79], v[88:91]
 v_mfma_f32_16x16x32_bf16 v[92:95], v[212:215], v[76:79], v[92:95]
 s_add_u32 m0, s54, 122880
 s_add_u32 s60, s59, 458752
 buffer_load_dwordx4 v6, s[16:19], s60 offen lds
 s_waitcnt lgkmcnt(2)
 v_mfma_f32_16x16x32_bf16 v[16:19], v[152:155], v[48:51], v[16:19]
 ds_read_b128 v[64:67], v8 offset:24576
 v_mfma_f32_16x16x32_bf16 v[20:23], v[216:219], v[48:51], v[20:23]
 ds_read_b128 v[68:71], v8 offset:26624
 v_mfma_f32_16x16x32_bf16 v[24:27], v[152:155], v[52:55], v[24:27]
 ds_read_b128 v[72:75], v9 offset:24576
 v_mfma_f32_16x16x32_bf16 v[28:31], v[216:219], v[52:55], v[28:31]
 ds_read_b128 v[76:79], v9 offset:26624
 s_waitcnt lgkmcnt(4)
 v_mfma_f32_16x16x32_bf16 v[80:83], v[152:155], v[56:59], v[80:83]
 v_mfma_f32_16x16x32_bf16 v[84:87], v[216:219], v[56:59], v[84:87]
 v_mfma_f32_16x16x32_bf16 v[88:91], v[152:155], v[60:63], v[88:91]
 v_mfma_f32_16x16x32_bf16 v[92:95], v[216:219], v[60:63], v[92:95]
 s_waitcnt vmcnt(10)
 s_waitcnt vmcnt(5)
 s_waitcnt lgkmcnt(0)
 s_barrier
 s_cmp_lg_u32 s50, 0
 s_cbranch_scc1 L_fl_16
 s_lshl_b32 s61, s81, 4
 s_add_u32 s61, s61, 12845056
 s_mov_b64 exec, 1
 buffer_store_dword v0, off, s[44:47], s61 sc1
 s_mov_b64 exec, -1
L_fl_16:
 v_add_u32 v8, 0xffff0000, v8
 v_add_u32 v9, 0xffff0000, v9
 v_mfma_f32_16x16x32_bf16 v[16:19], v[156:159], v[64:67], v[16:19]
 ds_read_b128 v[48:51], v8 offset:0
 s_lshl_b32 s68, s48, 2
 s_lshl_b32 s63, s51, 1
 s_add_u32 s68, s68, s63
 s_mul_i32 s68, s68, 28
 s_lshl_b32 s63, s49, 2
 s_add_u32 s68, s68, s63
 s_add_u32 s68, s68, s52
 s_lshl_b32 s68, s68, 10
 s_add_u32 s68, s68, 8388608
 s_add_u32 s78, s68, 28672
 v_lshlrev_b32 v96, 16, v7
 v_and_b32 v97, s67, v7
 v_mfma_f32_16x16x32_bf16 v[20:23], v[220:223], v[64:67], v[20:23]
 ds_read_b128 v[52:55], v8 offset:2048
 v_mfma_f32_16x16x32_bf16 v[24:27], v[156:159], v[68:71], v[24:27]
 ds_read_b128 v[56:59], v9 offset:0
 v_mfma_f32_16x16x32_bf16 v[28:31], v[220:223], v[68:71], v[28:31]
 ds_read_b128 v[60:63], v9 offset:2048
 s_add_u32 m0, s54, 65536
 s_add_u32 s60, s59, 262144
 buffer_load_dwordx4 v6, s[16:19], s60 offen lds
 v_mfma_f32_16x16x32_bf16 v[80:83], v[156:159], v[72:75], v[80:83]
 v_mfma_f32_16x16x32_bf16 v[84:87], v[220:223], v[72:75], v[84:87]
 v_mfma_f32_16x16x32_bf16 v[88:91], v[156:159], v[76:79], v[88:91]
 v_mfma_f32_16x16x32_bf16 v[92:95], v[220:223], v[76:79], v[92:95]
 s_add_u32 m0, s54, 73728
 s_add_u32 s60, s59, 327680
 buffer_load_dwordx4 v6, s[16:19], s60 offen lds
 s_waitcnt lgkmcnt(2)
 v_mfma_f32_16x16x32_bf16 v[16:19], v[160:163], v[48:51], v[16:19]
 ds_read_b128 v[64:67], v8 offset:8192
 v_mfma_f32_16x16x32_bf16 v[20:23], v[224:227], v[48:51], v[20:23]
 ds_read_b128 v[68:71], v8 offset:10240
 v_mfma_f32_16x16x32_bf16 v[24:27], v[160:163], v[52:55], v[24:27]
 ds_read_b128 v[72:75], v9 offset:8192
 v_mfma_f32_16x16x32_bf16 v[28:31], v[224:227], v[52:55], v[28:31]
 ds_read_b128 v[76:79], v9 offset:10240
 s_add_u32 m0, s54, 81920
 s_add_u32 s60, s59, 393216
 buffer_load_dwordx4 v6, s[16:19], s60 offen lds
 s_waitcnt lgkmcnt(4)
 v_mfma_f32_16x16x32_bf16 v[80:83], v[160:163], v[56:59], v[80:83]
 v_mfma_f32_16x16x32_bf16 v[84:87], v[224:227], v[56:59], v[84:87]
 v_mfma_f32_16x16x32_bf16 v[88:91], v[160:163], v[60:63], v[88:91]
 v_mfma_f32_16x16x32_bf16 v[92:95], v[224:227], v[60:63], v[92:95]
 s_add_u32 m0, s54, 90112
 s_add_u32 s60, s59, 196608
 buffer_load_dwordx4 v6, s[16:19], s60 offen lds
 s_waitcnt lgkmcnt(2)
 v_mfma_f32_16x16x32_bf16 v[16:19], v[164:167], v[64:67], v[16:19]
 ds_read_b128 v[48:51], v8 offset:16384
 s_cmp_lg_u32 s50, 1
 s_cbranch_scc1 L_pi_17
 s_lshl_b32 s62, s48, 10
 s_add_u32 s62, s62, 12845056
 v_lshl_add_u32 v13, v1, 7, s62
 s_xor_b32 s63, s81, 65
 s_lshl_b32 s63, s63, 4
 s_add_u32 s63, s63, 12845056
 v_writelane_b32 v13, s63, 7
 v_mov_b32 v12, 0
 s_mov_b64 exec, 0xff
 buffer_atomic_or v12, v13, s[44:47], 0 offen sc0 sc1
 s_mov_b64 exec, -1
L_pi_17:
 v_mfma_f32_16x16x32_bf16 v[20:23], v[228:231], v[64:67], v[20:23]
 ds_read_b128 v[52:55], v8 offset:18432
 v_mfma_f32_16x16x32_bf16 v[24:27], v[164:167], v[68:71], v[24:27]
 ds_read_b128 v[56:59], v9 offset:16384
 v_mfma_f32_16x16x32_bf16 v[28:31], v[228:231], v[68:71], v[28:31]
 ds_read_b128 v[60:63], v9 offset:18432
 s_waitcnt lgkmcnt(4)
 v_mfma_f32_16x16x32_bf16 v[80:83], v[164:167], v[72:75], v[80:83]
 v_mfma_f32_16x16x32_bf16 v[84:87], v[228:231], v[72:75], v[84:87]
 v_mfma_f32_16x16x32_bf16 v[88:91], v[164:167], v[76:79], v[88:91]
 v_mfma_f32_16x16x32_bf16 v[92:95], v[228:231], v[76:79], v[92:95]
 s_waitcnt lgkmcnt(2)
 v_mfma_f32_16x16x32_bf16 v[16:19], v[168:171], v[48:51], v[16:19]
 ds_read_b128 v[64:67], v8 offset:24576
 v_mfma_f32_16x16x32_bf16 v[20:23], v[232:235], v[48:51], v[20:23]
 ds_read_b128 v[68:71], v8 offset:26624
 v_mfma_f32_16x16x32_bf16 v[24:27], v[168:171], v[52:55], v[24:27]
 ds_read_b128 v[72:75], v9 offset:24576
 v_mfma_f32_16x16x32_bf16 v[28:31], v[232:235], v[52:55], v[28:31]
 ds_read_b128 v[76:79], v9 offset:26624
 s_waitcnt lgkmcnt(4)
 v_mfma_f32_16x16x32_bf16 v[80:83], v[168:171], v[56:59], v[80:83]
 v_mfma_f32_16x16x32_bf16 v[84:87], v[232:235], v[56:59], v[84:87]
 v_mfma_f32_16x16x32_bf16 v[88:91], v[168:171], v[60:63], v[88:91]
 v_mfma_f32_16x16x32_bf16 v[92:95], v[232:235], v[60:63], v[92:95]
 s_waitcnt vmcnt(8)
 s_waitcnt lgkmcnt(0)
 s_barrier
 v_mfma_f32_16x16x32_bf16 v[16:19], v[172:175], v[64:67], v[16:19]
 ds_read_b128 v[48:51], v8 offset:32768
 v_mfma_f32_16x16x32_bf16 v[20:23], v[236:239], v[64:67], v[20:23]
 ds_read_b128 v[52:55], v8 offset:34816
 v_mfma_f32_16x16x32_bf16 v[24:27], v[172:175], v[68:71], v[24:27]
 ds_read_b128 v[56:59], v9 offset:32768
 v_mfma_f32_16x16x32_bf16 v[28:31], v[236:239], v[68:71], v[28:31]
 ds_read_b128 v[60:63], v9 offset:34816
 s_lshl_b32 s71, s3, 9
 s_add_u32 s71, s71, s59
 s_add_u32 m0, s54, 0
 s_xor_b32 s60, s71, 0
 buffer_load_dwordx4 v6, s[32:35], s60 offen lds
 v_mfma_f32_16x16x32_bf16 v[80:83], v[172:175], v[72:75], v[80:83]
 v_mfma_f32_16x16x32_bf16 v[84:87], v[236:239], v[72:75], v[84:87]
 v_mfma_f32_16x16x32_bf16 v[88:91], v[172:175], v[76:79], v[88:91]
 v_mfma_f32_16x16x32_bf16 v[92:95], v[236:239], v[76:79], v[92:95]
 s_add_u32 m0, s54, 8192
 s_xor_b32 s60, s71, 65536
 buffer_load_dwordx4 v6, s[32:35], s60 offen lds
 s_waitcnt lgkmcnt(2)
 v_mfma_f32_16x16x32_bf16 v[16:19], v[176:179], v[48:51], v[16:19]
 ds_read_b128 v[64:67], v8 offset:40960
 s_cmp_lg_u32 s50, 1
 s_cbranch_scc1 L_ok_18
 s_waitcnt vmcnt(2)
 v_cmp_ne_u32 vcc, s53, v12
 s_nop 0
 s_and_b64 vcc, vcc, 0xff
 s_cbranch_vccz L_ok_18
 s_mov_b32 s70, 50000
L_spin_19:
 s_sleep 1
 v_mov_b32 v12, 0
 s_mov_b64 exec, 0xff
 buffer_atomic_or v12, v13, s[44:47], 0 offen sc0 sc1
 s_mov_b64 exec, -1
 s_waitcnt vmcnt(0)
 s_sub_u32 s70, s70, 1
 s_cbranch_scc1 L_ok_18
 v_cmp_ne_u32 vcc, s53, v12
 s_nop 0
 s_and_b64 vcc, vcc, 0xff
 s_cbranch_vccnz L_spin_19
L_ok_18:
 s_barrier
 s_lshl_b32 s80, s81, 11
 s_add_u32 s80, s80, 16777216
 buffer_load_dwordx4 v[104:107], v2, s[44:47], s80 offen offset:0 sc1
 buffer_load_dwordx4 v[108:111], v2, s[44:47], s80 offen offset:1024 sc1
 s_lshl_b32 s64, s48, 2
 s_add_u32 s64, s64, s52
 s_lshl_b32 s64, s64, 4
 s_add_u32 s64, s64, s51
 s_lshl_b32 s64, s64, 10
 s_add_u32 s64, s64, 4194304
 v_mfma_f32_16x16x32_bf16 v[20:23], v[240:243], v[48:51], v[20:23]
 ds_read_b128 v[68:71], v8 offset:43008
 v_mfma_f32_16x16x32_bf16 v[24:27], v[176:179], v[52:55], v[24:27]
 ds_read_b128 v[72:75], v9 offset:40960
 v_mfma_f32_16x16x32_bf16 v[28:31], v[240:243], v[52:55], v[28:31]
 ds_read_b128 v[76:79], v9 offset:43008
 s_waitcnt lgkmcnt(4)
 v_mfma_f32_16x16x32_bf16 v[80:83], v[176:179], v[56:59], v[80:83]
 v_mfma_f32_16x16x32_bf16 v[84:87], v[240:243], v[56:59], v[84:87]
 v_mfma_f32_16x16x32_bf16 v[88:91], v[176:179], v[60:63], v[88:91]
 v_mfma_f32_16x16x32_bf16 v[92:95], v[240:243], v[60:63], v[92:95]
 s_add_u32 s60, s64, 0
 buffer_load_dwordx4 v[128:131], v2, s[44:47], s60 offen sc1
 s_waitcnt lgkmcnt(2)
 v_mfma_f32_16x16x32_bf16 v[16:19], v[180:183], v[64:67], v[16:19]
 ds_read_b128 v[48:51], v8 offset:49152
 v_mfma_f32_16x16x32_bf16 v[20:23], v[244:247], v[64:67], v[20:23]
 ds_read_b128 v[52:55], v8 offset:51200
 v_mfma_f32_16x16x32_bf16 v[24:27], v[180:183], v[68:71], v[24:27]
 ds_read_b128 v[56:59], v9 offset:49152
 v_mfma_f32_16x16x32_bf16 v[28:31], v[244:247], v[68:71], v[28:31]
 ds_read_b128 v[60:63], v9 offset:51200
 s_waitcnt lgkmcnt(4)
 v_mfma_f32_16x16x32_bf16 v[80:83], v[180:183], v[72:75], v[80:83]
 v_mfma_f32_16x16x32_bf16 v[84:87], v[244:247], v[72:75], v[84:87]
 v_mfma_f32_16x16x32_bf16 v[88:91], v[180:183], v[76:79], v[88:91]
 v_mfma_f32_16x16x32_bf16 v[92:95], v[244:247], v[76:79], v[92:95]
 s_add_u32 s60, s64, 2048
 buffer_load_dwordx4 v[132:135], v2, s[44:47], s60 offen sc1
 s_waitcnt lgkmcnt(2)
 v_mfma_f32_16x16x32_bf16 v[16:19], v[184:187], v[48:51], v[16:19]
 ds_read_b128 v[64:67], v8 offset:57344
 v_mfma_f32_16x16x32_bf16 v[20:23], v[248:251], v[48:51], v[20:23]
 ds_read_b128 v[68:71], v8 offset:59392
 v_mfma_f32_16x16x32_bf16 v[24:27], v[184:187], v[52:55], v[24:27]
 ds_read_b128 v[72:75], v9 offset:57344
 v_mfma_f32_16x16x32_bf16 v[28:31], v[248:251], v[52:55], v[28:31]
 ds_read_b128 v[76:79], v9 offset:59392
 s_waitcnt lgkmcnt(4)
 v_mfma_f32_16x16x32_bf16 v[80:83], v[184:187], v[56:59], v[80:83]
 v_mfma_f32_16x16x32_bf16 v[84:87], v[248:251], v[56:59], v[84:87]
 v_mfma_f32_16x16x32_bf16 v[88:91], v[184:187], v[60:63], v[88:91]
 v_mfma_f32_16x16x32_bf16 v[92:95], v[248:251], v[60:63], v[92:95]
 s_add_u32 s60, s64, 4096
 buffer_load_dwordx4 v[136:139], v2, s[44:47], s60 offen sc1
 s_waitcnt lgkmcnt(2)
 v_mfma_f32_16x16x32_bf16 v[16:19], v[188:191], v[64:67], v[16:19]
 v_mfma_f32_16x16x32_bf16 v[20:23], v[252:255], v[64:67], v[20:23]
 v_mfma_f32_16x16x32_bf16 v[24:27], v[188:191], v[68:71], v[24:27]
 v_mfma_f32_16x16x32_bf16 v[28:31], v[252:255], v[68:71], v[28:31]
 s_waitcnt lgkmcnt(0)
 v_mfma_f32_16x16x32_bf16 v[80:83], v[188:191], v[72:75], v[80:83]
 v_mfma_f32_16x16x32_bf16 v[84:87], v[252:255], v[72:75], v[84:87]
 v_mfma_f32_16x16x32_bf16 v[88:91], v[188:191], v[76:79], v[88:91]
 v_mfma_f32_16x16x32_bf16 v[92:95], v[252:255], v[76:79], v[92:95]
 s_add_u32 s60, s64, 14336
 buffer_load_dwordx4 v[140:143], v2, s[44:47], s60 offen sc1
 s_nop 2
 ds_write_b128 v10, v[80:83] offset:0
 ds_write_b128 v10, v[84:87] offset:1024
 ds_write_b128 v10, v[88:91] offset:2048
 ds_write_b128 v10, v[92:95] offset:3072
 v_add_f32 v16, v16, v96
 s_add_u32 s60, s64, 8192
 buffer_load_dwordx4 v[144:147], v2, s[44:47], s60 offen sc1
 v_add_f32 v17, v17, v96
 v_add_f32 v18, v18, v96
 v_add_f32 v19, v19, v96
 v_add_f32 v20, v20, v96
 s_add_u32 s60, s64, 10240
 buffer_load_dwordx4 v[148:151], v2, s[44:47], s60 offen sc1
 v_add_f32 v21, v21, v96
 v_add_f32 v22, v22, v96
 v_add_f32 v23, v23, v96
 v_add_f32 v24, v24, v97
 s_add_u32 s60, s64, 12288
 buffer_load_dwordx4 v[152:155], v2, s[44:47], s60 offen sc1
 v_add_f32 v25, v25, v97
 v_add_f32 v26, v26, v97
 v_add_f32 v27, v27, v97
 v_add_f32 v28, v28, v97
 v_add_f32 v29, v29, v97
 v_add_f32 v30, v30, v97
 v_add_f32 v31, v31, v97
 v_mov_b32 v98, 0xffff0000
 s_waitcnt vmcnt(7)
 v_lshlrev_b32 v112, 16, v104
 v_and_b32 v113, v98, v104
 v_lshlrev_b32 v114, 16, v105
 v_and_b32 v115, v98, v105
 v_lshlrev_b32 v116, 16, v106
 v_and_b32 v117, v98, v106
 v_lshlrev_b32 v118, 16, v107
 v_and_b32 v119, v98, v107
 v_lshlrev_b32 v120, 16, v108
 v_and_b32 v121, v98, v108
 v_lshlrev_b32 v122, 16, v109
 v_and_b32 v123, v98, v109
 v_lshlrev_b32 v124, 16, v110
 v_and_b32 v125, v98, v110
 v_lshlrev_b32 v126, 16, v111
 v_and_b32 v127, v98, v111
 s_waitcnt lgkmcnt(0)
 s_barrier
 ds_read_b128 v[80:83], v11 offset:0
 ds_read_b128 v[84:87], v11 offset:1024
 ds_read_b128 v[88:91], v11 offset:2048
 ds_read_b128 v[92:95], v11 offset:3072
 v_pk_add_f32 v[16:17], v[16:17], v[112:113]
 v_pk_add_f32 v[18:19], v[18:19], v[114:115]
 v_pk_add_f32 v[20:21], v[20:21], v[116:117]
 v_pk_add_f32 v[22:23], v[22:23], v[118:119]
 v_pk_add_f32 v[24:25], v[24:25], v[120:121]
 v_pk_add_f32 v[26:27], v[26:27], v[122:123]
 v_pk_add_f32 v[28:29], v[28:29], v[124:125]
 v_pk_add_f32 v[30:31], v[30:31], v[126:127]
 v_pk_mul_f32 v[16:17], v[16:17], v[32:33]
 v_pk_mul_f32 v[18:19], v[18:19], v[34:35]
 v_pk_mul_f32 v[20:21], v[20:21], v[36:37]
 v_pk_mul_f32 v[22:23], v[22:23], v[38:39]
 v_pk_mul_f32 v[24:25], v[24:25], v[40:41]
 v_pk_mul_f32 v[26:27], v[26:27], v[42:43]
 v_pk_mul_f32 v[28:29], v[28:29], v[44:45]
 v_pk_mul_f32 v[30:31], v[30:31], v[46:47]
 s_waitcnt lgkmcnt(3)
 v_pk_fma_f32 v[16:17], v[80:81], v[32:33], v[16:17]
 v_pk_fma_f32 v[18:19], v[82:83], v[34:35], v[18:19]
 s_waitcnt lgkmcnt(2)
 v_pk_fma_f32 v[20:21], v[84:85], v[36:37], v[20:21]
 v_pk_fma_f32 v[22:23], v[86:87], v[38:39], v[22:23]
 v_cvt_pk_bf16_f32 v80, v16, v17
 v_cvt_pk_bf16_f32 v81, v18, v19
 v_cvt_pk_bf16_f32 v82, v20, v21
 v_cvt_pk_bf16_f32 v83, v22, v23
 buffer_store_dwordx4 v[80:83], v2, s[44:47], s68 offen sc1
 s_waitcnt lgkmcnt(1)
 v_pk_fma_f32 v[24:25], v[88:89], v[40:41], v[24:25]
 v_pk_fma_f32 v[26:27], v[90:91], v[42:43], v[26:27]
 s_waitcnt lgkmcnt(0)
 v_pk_fma_f32 v[28:29], v[92:93], v[44:45], v[28:29]
 v_pk_fma_f32 v[30:31], v[94:95], v[46:47], v[30:31]
 v_cvt_pk_bf16_f32 v88, v24, v25
 v_cvt_pk_bf16_f32 v89, v26, v27
 v_cvt_pk_bf16_f32 v90, v28, v29
 v_cvt_pk_bf16_f32 v91, v30, v31
 buffer_store_dwordx4 v[88:91], v2, s[44:47], s78 offen sc1
 s_cmp_lg_u32 s50, 1
 s_cbranch_scc1 L_pi_20
 s_lshl_b32 s62, s48, 10
 s_add_u32 s62, s62, 12845952
 v_mov_b32 v13, s62
 v_mov_b32 v12, 0
 s_mov_b64 exec, 0x1
 buffer_atomic_or v12, v13, s[44:47], 0 offen sc0 sc1
 s_mov_b64 exec, -1
L_pi_20:
 v_add_u32 v8, 65536, v3
 v_xor_b32 v9, 32, v8
 v_xor_b32 v10, 64, v8
 v_xor_b32 v11, 96, v8
 ds_read_b64_tr_b16 v[48:49], v8 offset:32768
 ds_read_b64_tr_b16 v[50:51], v10 offset:33280
 ds_read_b64_tr_b16 v[52:53], v9 offset:32768
 ds_read_b64_tr_b16 v[54:55], v11 offset:33280
 ds_read_b64_tr_b16 v[56:57], v10 offset:32768
 ds_read_b64_tr_b16 v[58:59], v8 offset:33280
 ds_read_b64_tr_b16 v[60:61], v11 offset:32768
 ds_read_b64_tr_b16 v[62:63], v9 offset:33280
 s_waitcnt vmcnt(8)
 s_waitcnt lgkmcnt(6)
 v_mfma_f32_16x16x32_bf16 v[96:99], v[48:51], v[128:131], 0
 ds_read_b64_tr_b16 v[64:65], v8 offset:40960
 ds_read_b64_tr_b16 v[66:67], v10 offset:41472
 v_and_b32 v16, 15, v1
 s_waitcnt lgkmcnt(6)
 v_mfma_f32_16x16x32_bf16 v[100:103], v[52:55], v[128:131], 0
 ds_read_b64_tr_b16 v[68:69], v9 offset:40960
 ds_read_b64_tr_b16 v[70:71], v11 offset:41472
 v_lshrrev_b32 v17, 4, v1
 s_waitcnt lgkmcnt(6)
 v_mfma_f32_16x16x32_bf16 v[104:107], v[56:59], v[128:131], 0
 ds_read_b64_tr_b16 v[72:73], v10 offset:40960
 ds_read_b64_tr_b16 v[74:75], v8 offset:41472
 v_and_b32 v18, 7, v1
 s_waitcnt lgkmcnt(6)
 v_mfma_f32_16x16x32_bf16 v[108:111], v[60:63], v[128:131], 0
 ds_read_b64_tr_b16 v[76:77], v11 offset:40960
 ds_read_b64_tr_b16 v[78:79], v9 offset:41472
 v_xor_b32 v17, v17, v18
 s_waitcnt vmcnt(7)
 s_waitcnt lgkmcnt(6)
 v_mfma_f32_16x16x32_bf16 v[96:99], v[64:67], v[132:135], v[96:99]
 ds_read_b64_tr_b16 v[48:49], v8 offset:49152
 ds_read_b64_tr_b16 v[50:51], v10 offset:49664
 s_lshl_b32 s62, s51, 3
 v_xor_b32 v17, s62, v17
 s_waitcnt lgkmcnt(6)
 v_mfma_f32_16x16x32_bf16 v[100:103], v[68:71], v[132:135], v[100:103]
 ds_read_b64_tr_b16 v[52:53], v9 offset:49152
 ds_read_b64_tr_b16 v[54:55], v11 offset:49664
 v_lshlrev_b32 v17, 4, v17
 s_waitcnt lgkmcnt(6)
 v_mfma_f32_16x16x32_bf16 v[104:107], v[72:75], v[132:135], v[104:107]
 ds_read_b64_tr_b16 v[56:57], v10 offset:49152
 ds_read_b64_tr_b16 v[58:59], v8 offset:49664
 v_lshl_add_u32 v14, v16, 8, v17
 s_waitcnt lgkmcnt(6)
 v_mfma_f32_16x16x32_bf16 v[108:111], v[76:79], v[132:135], v[108:111]
 ds_read_b64_tr_b16 v[60:61], v11 offset:49152
 ds_read_b64_tr_b16 v[62:63], v9 offset:49664
 s_lshl_b32 s62, s50, 12
 s_add_u32 s62, s62, 131072
 v_add_u32 v14, s62, v14
 s_waitcnt vmcnt(6)
 s_waitcnt lgkmcnt(6)
 v_mfma_f32_16x16x32_bf16 v[96:99], v[48:51], v[136:139], v[96:99]
 ds_read_b64_tr_b16 v[64:65], v8 offset:57344
 ds_read_b64_tr_b16 v[66:67], v10 offset:57856
 v_xor_b32 v3, 64, v14
 s_waitcnt lgkmcnt(6)
 v_mfma_f32_16x16x32_bf16 v[100:103], v[52:55], v[136:139], v[100:103]
 ds_read_b64_tr_b16 v[68:69], v9 offset:57344
 ds_read_b64_tr_b16 v[70:71], v11 offset:57856
 v_xor_b32 v5, 192, v14
 s_waitcnt lgkmcnt(6)
 v_mfma_f32_16x16x32_bf16 v[104:107], v[56:59], v[136:139], v[104:107]
 ds_read_b64_tr_b16 v[72:73], v10 offset:57344
 ds_read_b64_tr_b16 v[74:75], v8 offset:57856
 v_lshrrev_b32 v16, 3, v1
 s_waitcnt lgkmcnt(6)
 v_mfma_f32_16x16x32_bf16 v[108:111], v[60:63], v[136:139], v[108:111]
 ds_read_b64_tr_b16 v[76:77], v11 offset:57344
 ds_read_b64_tr_b16 v[78:79], v9 offset:57856
 v_lshlrev_b32 v18, 1, v18
 s_cmp_lg_u32 s50, 1
 s_cbranch_scc1 L_ok_21
 s_waitcnt vmcnt(0)
 v_cmp_ne_u32 vcc, s53, v12
 s_nop 0
 s_and_b64 vcc, vcc, 0x1
 s_cbranch_vccz L_ok_21
 s_mov_b32 s70, 50000
L_spin_22:
 s_sleep 1
 v_mov_b32 v12, 0
 s_mov_b64 exec, 0x1
 buffer_atomic_or v12, v13, s[44:47], 0 offen sc0 sc1
 s_mov_b64 exec, -1
 s_waitcnt vmcnt(0)
 s_sub_u32 s70, s70, 1
 s_cbranch_scc1 L_ok_21
 v_cmp_ne_u32 vcc, s53, v12
 s_nop 0
 s_and_b64 vcc, vcc, 0x1
 s_cbranch_vccnz L_spin_22
L_ok_21:
 s_waitcnt vmcnt(0)
 s_waitcnt lgkmcnt(0)
 s_barrier
 s_cmp_lg_u32 s50, 0
 s_cbranch_scc1 L_fl_23
 s_lshl_b32 s61, s81, 4
 s_add_u32 s61, s61, 13107200
 s_mov_b64 exec, 1
 buffer_store_dword v0, off, s[44:47], s61 sc1
 s_mov_b64 exec, -1
L_fl_23:
 s_add_u32 s60, s64, 6144
 buffer_load_dwordx4 v[156:159], v2, s[44:47], s60 offen sc1
 v_mfma_f32_16x16x32_bf16 v[96:99], v[64:67], v[140:143], v[96:99]
 ds_read_b64_tr_b16 v[48:49], v8 offset:0
 ds_read_b64_tr_b16 v[50:51], v10 offset:512
 s_add_u32 m0, s54, 16384
 s_xor_b32 s60, s71, 131072
 buffer_load_dwordx4 v6, s[32:35], s60 offen lds
 v_xor_b32 v18, v18, v16
 v_mfma_f32_16x16x32_bf16 v[100:103], v[68:71], v[140:143], v[100:103]
 ds_read_b64_tr_b16 v[52:53], v9 offset:0
 ds_read_b64_tr_b16 v[54:55], v11 offset:512
 s_add_u32 m0, s54, 24576
 s_xor_b32 s60, s71, 196608
 buffer_load_dwordx4 v6, s[32:35], s60 offen lds
 v_lshlrev_b32 v18, 4, v18
 v_mfma_f32_16x16x32_bf16 v[104:107], v[72:75], v[140:143], v[104:107]
 ds_read_b64_tr_b16 v[56:57], v10 offset:0
 ds_read_b64_tr_b16 v[58:59], v8 offset:512
 s_lshl_b32 s71, s3, 9
 s_add_u32 s71, s71, s59
 s_add_u32 m0, s54, 32768
 s_xor_b32 s60, s71, 262144
 buffer_load_dwordx4 v6, s[32:35], s60 offen lds
 v_lshl_add_u32 v15, v16, 8, v18
 v_mfma_f32_16x16x32_bf16 v[108:111], v[76:79], v[140:143], v[108:111]
 ds_read_b64_tr_b16 v[60:61], v11 offset:0
 ds_read_b64_tr_b16 v[62:63], v9 offset:512
 s_add_u32 m0, s54, 40960
 s_xor_b32 s60, s71, 327680
 buffer_load_dwordx4 v6, s[32:35], s60 offen lds
 s_lshl_b32 s62, s50, 11
 s_add_u32 s62, s62, 131072
 v_add_u32 v15, s62, v15
 s_waitcnt lgkmcnt(6)
 v_mfma_f32_16x16x32_bf16 v[96:99], v[48:51], v[144:147], v[96:99]
 ds_read_b64_tr_b16 v[64:65], v8 offset:8192
 ds_read_b64_tr_b16 v[66:67], v10 offset:8704
 v_xor_b32 v7, 16, v15
 s_waitcnt lgkmcnt(6)
 v_mfma_f32_16x16x32_bf16 v[100:103], v[52:55], v[144:147], v[100:103]
 ds_read_b64_tr_b16 v[68:69], v9 offset:8192
 ds_read_b64_tr_b16 v[70:71], v11 offset:8704
 s_add_u32 m0, s54, 49152
 s_xor_b32 s60, s71, 393216
 buffer_load_dwordx4 v6, s[32:35], s60 offen lds
 s_lshl_b32 s68, s48, 2
 s_add_u32 s68, s68, s52
 s_mul_i32 s68, s68, 28
 s_waitcnt lgkmcnt(6)
 v_mfma_f32_16x16x32_bf16 v[104:107], v[56:59], v[144:147], v[104:107]
 ds_read_b64_tr_b16 v[72:73], v10 offset:8192
 ds_read_b64_tr_b16 v[74:75], v8 offset:8704
 s_add_u32 s68, s68, s51
 s_lshl_b32 s68, s68, 10
 s_add_u32 s68, s68, 8388608
 s_waitcnt lgkmcnt(6)
 v_mfma_f32_16x16x32_bf16 v[108:111], v[60:63], v[144:147], v[108:111]
 ds_read_b64_tr_b16 v[76:77], v11 offset:8192
 ds_read_b64_tr_b16 v[78:79], v9 offset:8704
 s_add_u32 m0, s54, 57344
 s_xor_b32 s60, s71, 458752
 buffer_load_dwordx4 v6, s[32:35], s60 offen lds
 s_waitcnt lgkmcnt(6)
 v_mfma_f32_16x16x32_bf16 v[96:99], v[64:67], v[148:151], v[96:99]
 ds_read_b64_tr_b16 v[48:49], v8 offset:16384
 ds_read_b64_tr_b16 v[50:51], v10 offset:16896
 s_waitcnt lgkmcnt(6)
 v_mfma_f32_16x16x32_bf16 v[100:103], v[68:71], v[148:151], v[100:103]
 ds_read_b64_tr_b16 v[52:53], v9 offset:16384
 ds_read_b64_tr_b16 v[54:55], v11 offset:16896
 s_lshl_b32 s71, s3, 9
 s_add_u32 s71, s71, s59
 s_add_u32 m0, s54, 98304
 s_xor_b32 s60, s71, 524288
 buffer_load_dwordx4 v6, s[32:35], s60 offen lds
 s_waitcnt lgkmcnt(6)
 v_mfma_f32_16x16x32_bf16 v[104:107], v[72:75], v[148:151], v[104:107]
 ds_read_b64_tr_b16 v[56:57], v10 offset:16384
 ds_read_b64_tr_b16 v[58:59], v8 offset:16896
 s_waitcnt lgkmcnt(6)
 v_mfma_f32_16x16x32_bf16 v[108:111], v[76:79], v[148:151], v[108:111]
 ds_read_b64_tr_b16 v[60:61], v11 offset:16384
 ds_read_b64_tr_b16 v[62:63], v9 offset:16896
 s_add_u32 m0, s54, 106496
 s_xor_b32 s60, s71, 589824
 buffer_load_dwordx4 v6, s[32:35], s60 offen lds
 v_lshrrev_b32 v160, 3, v1
 v_and_b32 v161, 0x70, v2
 v_lshl_add_u32 v160, v160, 11, v161
 s_lshr_b32 s79, s69, 12
 s_lshl_b32 s79, s79, 10
 s_lshl_b32 s62, s65, 7
 s_add_u32 s79, s79, s62
 buffer_load_dwordx4 v[162:165], v160, s[8:11], s79 offen
 s_waitcnt lgkmcnt(6)
 v_mfma_f32_16x16x32_bf16 v[96:99], v[48:51], v[152:155], v[96:99]
 ds_read_b64_tr_b16 v[64:65], v8 offset:24576
 ds_read_b64_tr_b16 v[66:67], v10 offset:25088
 s_waitcnt lgkmcnt(6)
 v_mfma_f32_16x16x32_bf16 v[100:103], v[52:55], v[152:155], v[100:103]
 ds_read_b64_tr_b16 v[68:69], v9 offset:24576
 ds_read_b64_tr_b16 v[70:71], v11 offset:25088
 s_add_u32 m0, s54, 114688
 s_xor_b32 s60, s71, 655360
 buffer_load_dwordx4 v6, s[32:35], s60 offen lds
 s_waitcnt lgkmcnt(6)
 v_mfma_f32_16x16x32_bf16 v[104:107], v[56:59], v[152:155], v[104:107]
 ds_read_b64_tr_b16 v[72:73], v10 offset:24576
 ds_read_b64_tr_b16 v[74:75], v8 offset:25088
 s_waitcnt lgkmcnt(6)
 v_mfma_f32_16x16x32_bf16 v[108:111], v[60:63], v[152:155], v[108:111]
 ds_read_b64_tr_b16 v[76:77], v11 offset:24576
 ds_read_b64_tr_b16 v[78:79], v9 offset:25088
 s_add_u32 m0, s54, 122880
 s_xor_b32 s60, s71, 720896
 buffer_load_dwordx4 v6, s[32:35], s60 offen lds
 s_waitcnt vmcnt(11)
 s_waitcnt lgkmcnt(6)
 v_mfma_f32_16x16x32_bf16 v[96:99], v[64:67], v[156:159], v[96:99]
 s_waitcnt lgkmcnt(4)
 v_mfma_f32_16x16x32_bf16 v[100:103], v[68:71], v[156:159], v[100:103]
 s_waitcnt lgkmcnt(2)
 v_mfma_f32_16x16x32_bf16 v[104:107], v[72:75], v[156:159], v[104:107]
 s_waitcnt lgkmcnt(0)
 v_mfma_f32_16x16x32_bf16 v[108:111], v[76:79], v[156:159], v[108:111]
 s_cmp_lg_u32 s50, 1
 s_cbranch_scc1 L_pi_24
 s_lshl_b32 s62, s48, 10
 s_add_u32 s62, s62, 13107200
 v_lshl_add_u32 v13, v1, 7, s62
 v_mov_b32 v12, 0
 s_mov_b64 exec, 0x7f
 buffer_atomic_or v12, v13, s[44:47], 0 offen sc0 sc1
 s_mov_b64 exec, -1
L_pi_24:
 v_add_u32 v8, 0, v4
 v_xor_b32 v9, 32, v8
 v_xor_b32 v10, 64, v8
 v_xor_b32 v11, 96, v8
 v_xor_b32 v4, 128, v14
 ds_write_b128 v14, v[96:99]
 ds_write_b128 v3, v[100:103]
 ds_write_b128 v4, v[104:107]
 ds_write_b128 v5, v[108:111]
 s_waitcnt vmcnt(5)
 s_cmp_lg_u32 s50, 1
 s_cbranch_scc1 L_ok_25
 s_waitcnt vmcnt(0)
 v_cmp_ne_u32 vcc, s53, v12
 s_nop 0
 s_and_b64 vcc, vcc, 0x7f
 s_cbranch_vccz L_ok_25
 s_mov_b32 s70, 50000
L_spin_26:
 s_sleep 1
 v_mov_b32 v12, 0
 s_mov_b64 exec, 0x7f
 buffer_atomic_or v12, v13, s[44:47], 0 offen sc0 sc1
 s_mov_b64 exec, -1
 s_waitcnt vmcnt(0)
 s_sub_u32 s70, s70, 1
 s_cbranch_scc1 L_ok_25
 v_cmp_ne_u32 vcc, s53, v12
 s_nop 0
 s_and_b64 vcc, vcc, 0x7f
 s_cbranch_vccnz L_spin_26
L_ok_25:
 s_waitcnt lgkmcnt(0)
 s_barrier
 s_lshl_b32 s71, s3, 9
 s_add_u32 s71, s71, s59
 s_add_u32 m0, s54, 65536
 s_xor_b32 s60, s71, 786432
 buffer_load_dwordx4 v6, s[32:35], s60 offen lds
 s_add_u32 m0, s54, 73728
 s_xor_b32 s60, s71, 851968
 buffer_load_dwordx4 v6, s[32:35], s60 offen lds
 s_add_u32 s60, s68, 0
 buffer_load_dwordx4 v[168:171], v2, s[44:47], s60 offen offset:0 sc1
 buffer_load_dwordx4 v[172:175], v2, s[44:47], s60 offen offset:2048 sc1
 s_add_u32 s60, s68, 4096
 buffer_load_dwordx4 v[176:179], v2, s[44:47], s60 offen offset:0 sc1
 buffer_load_dwordx4 v[180:183], v2, s[44:47], s60 offen offset:2048 sc1
 ds_read_b128 v[96:99], v15 offset:0
 ds_read_b128 v[100:103], v7 offset:0
 ds_read_b128 v[104:107], v15 offset:16384
 ds_read_b128 v[108:111], v7 offset:16384
 ds_read_b64_tr_b16 v[16:17], v8 offset:0
 ds_read_b64_tr_b16 v[18:19], v8 offset:8192
 ds_read_b64_tr_b16 v[20:21], v9 offset:0
 ds_read_b64_tr_b16 v[22:23], v9 offset:8192
 ds_read_b64_tr_b16 v[24:25], v10 offset:0
 ds_read_b64_tr_b16 v[26:27], v10 offset:8192
 ds_read_b64_tr_b16 v[28:29], v11 offset:0
 ds_read_b64_tr_b16 v[30:31], v11 offset:8192
 s_add_u32 s60, s68, 8192
 buffer_load_dwordx4 v[184:187], v2, s[44:47], s60 offen offset:0 sc1
 ds_read_b64_tr_b16 v[32:33], v8 offset:4096
 ds_read_b64_tr_b16 v[34:35], v8 offset:12288
 ds_read_b64_tr_b16 v[36:37], v9 offset:4096
 ds_read_b64_tr_b16 v[38:39], v9 offset:12288
 ds_read_b64_tr_b16 v[40:41], v10 offset:4096
 ds_read_b64_tr_b16 v[42:43], v10 offset:12288
 ds_read_b64_tr_b16 v[44:45], v11 offset:4096
 ds_read_b64_tr_b16 v[46:47], v11 offset:12288
 buffer_load_dwordx4 v[188:191], v2, s[44:47], s60 offen offset:2048 sc1
 ds_read_b64_tr_b16 v[48:49], v8 offset:16384
 ds_read_b64_tr_b16 v[50:51], v8 offset:24576
 ds_read_b64_tr_b16 v[52:53], v9 offset:16384
 ds_read_b64_tr_b16 v[54:55], v9 offset:24576
 ds_read_b64_tr_b16 v[56:57], v10 offset:16384
 ds_read_b64_tr_b16 v[58:59], v10 offset:24576
 ds_read_b64_tr_b16 v[60:61], v11 offset:16384
 ds_read_b64_tr_b16 v[62:63], v11 offset:24576
 ds_read_b64_tr_b16 v[64:65], v8 offset:20480
 ds_read_b64_tr_b16 v[66:67], v8 offset:28672
 ds_read_b64_tr_b16 v[68:69], v9 offset:20480
 ds_read_b64_tr_b16 v[70:71], v9 offset:28672
 ds_read_b64_tr_b16 v[72:73], v10 offset:20480
 ds_read_b64_tr_b16 v[74:75], v10 offset:28672
 ds_read_b64_tr_b16 v[76:77], v11 offset:20480
 ds_read_b64_tr_b16 v[78:79], v11 offset:28672
 ds_read_b64_tr_b16 v[80:81], v8 offset:32768
 ds_read_b64_tr_b16 v[82:83], v8 offset:40960
 ds_read_b64_tr_b16 v[84:85], v9 offset:32768
 ds_read_b64_tr_b16 v[86:87], v9 offset:40960
 ds_read_b64_tr_b16 v[88:89], v10 offset:32768
 ds_read_b64_tr_b16 v[90:91], v10 offset:40960
 ds_read_b64_tr_b16 v[92:93], v11 offset:32768
 ds_read_b64_tr_b16 v[94:95], v11 offset:40960
 ds_read_b64_tr_b16 v[128:129], v8 offset:36864
 ds_read_b64_tr_b16 v[130:131], v8 offset:45056
 ds_read_b64_tr_b16 v[132:133], v9 offset:36864
 ds_read_b64_tr_b16 v[134:135], v9 offset:45056
 ds_read_b64_tr_b16 v[136:137], v10 offset:36864
 ds_read_b64_tr_b16 v[138:139], v10 offset:45056
 ds_read_b64_tr_b16 v[140:141], v11 offset:36864
 ds_read_b64_tr_b16 v[142:143], v11 offset:45056
 ds_read_b64_tr_b16 v[144:145], v8 offset:49152
 ds_read_b64_tr_b16 v[146:147], v8 offset:57344
 ds_read_b64_tr_b16 v[148:149], v9 offset:49152
 ds_read_b64_tr_b16 v[150:151], v9 offset:57344
 ds_read_b64_tr_b16 v[152:153], v10 offset:49152
 ds_read_b64_tr_b16 v[154:155], v10 offset:57344
 ds_read_b64_tr_b16 v[156:157], v11 offset:49152
 ds_read_b64_tr_b16 v[158:159], v11 offset:57344
 ds_read_b64_tr_b16 v[224:225], v8 offset:53248
 ds_read_b64_tr_b16 v[226:227], v8 offset:61440
 ds_read_b64_tr_b16 v[228:229], v9 offset:53248
 ds_read_b64_tr_b16 v[230:231], v9 offset:61440
 ds_read_b64_tr_b16 v[232:233], v10 offset:53248
 ds_read_b64_tr_b16 v[234:235], v10 offset:61440
 ds_read_b64_tr_b16 v[236:237], v11 offset:53248
 ds_read_b64_tr_b16 v[238:239], v11 offset:61440
 s_waitcnt lgkmcnt(15)
 v_add_f32 v96, v96, v104
 v_add_f32 v97, v97, v105
 v_add_f32 v98, v98, v106
 v_add_f32 v99, v99, v107
 v_add_f32 v100, v100, v108
 v_add_f32 v101, v101, v109
 v_add_f32 v102, v102, v110
 v_add_f32 v103, v103, v111
 s_waitcnt vmcnt(10)
 v_lshlrev_b32 v104, 16, v162
 v_and_b32 v105, s67, v162
 v_lshlrev_b32 v106, 16, v163
 v_and_b32 v107, s67, v163
 v_lshlrev_b32 v108, 16, v164
 v_and_b32 v109, s67, v164
 v_lshlrev_b32 v110, 16, v165
 v_and_b32 v111, s67, v165
 s_waitcnt vmcnt(5)
 v_mfma_f32_16x16x32_bf16 v[112:115], v[16:19], v[168:171], 0
 s_add_u32 s60, s68, 12288
 buffer_load_dwordx4 v[192:195], v2, s[44:47], s60 offen offset:0 sc1
 v_mfma_f32_16x16x32_bf16 v[116:119], v[20:23], v[168:171], 0
 v_mfma_f32_16x16x32_bf16 v[120:123], v[24:27], v[168:171], 0
 v_mfma_f32_16x16x32_bf16 v[124:127], v[28:31], v[168:171], 0
 s_waitcnt vmcnt(5)
 v_mfma_f32_16x16x32_bf16 v[112:115], v[32:35], v[172:175], v[112:115]
 buffer_load_dwordx4 v[196:199], v2, s[44:47], s60 offen offset:2048 sc1
 v_mfma_f32_16x16x32_bf16 v[116:119], v[36:39], v[172:175], v[116:119]
 v_mfma_f32_16x16x32_bf16 v[120:123], v[40:43], v[172:175], v[120:123]
 v_mfma_f32_16x16x32_bf16 v[124:127], v[44:47], v[172:175], v[124:127]
 s_waitcnt vmcnt(5)
 v_mfma_f32_16x16x32_bf16 v[112:115], v[48:51], v[176:179], v[112:115]
 s_add_u32 s60, s68, 16384
 buffer_load_dwordx4 v[200:203], v2, s[44:47], s60 offen offset:0 sc1
 v_mfma_f32_16x16x32_bf16 v[116:119], v[52:55], v[176:179], v[116:119]
 v_mfma_f32_16x16x32_bf16 v[120:123], v[56:59], v[176:179], v[120:123]
 v_mfma_f32_16x16x32_bf16 v[124:127], v[60:63], v[176:179], v[124:127]
 s_waitcnt vmcnt(5)
 v_mfma_f32_16x16x32_bf16 v[112:115], v[64:67], v[180:183], v[112:115]
 buffer_load_dwordx4 v[204:207], v2, s[44:47], s60 offen offset:2048 sc1
 v_mfma_f32_16x16x32_bf16 v[116:119], v[68:71], v[180:183], v[116:119]
 v_mfma_f32_16x16x32_bf16 v[120:123], v[72:75], v[180:183], v[120:123]
 v_mfma_f32_16x16x32_bf16 v[124:127], v[76:79], v[180:183], v[124:127]
 s_waitcnt vmcnt(5)
 v_mfma_f32_16x16x32_bf16 v[112:115], v[80:83], v[184:187], v[112:115]
 s_add_u32 s60, s68, 20480
 buffer_load_dwordx4 v[208:211], v2, s[44:47], s60 offen offset:0 sc1
 v_mfma_f32_16x16x32_bf16 v[116:119], v[84:87], v[184:187], v[116:119]
 v_mfma_f32_16x16x32_bf16 v[120:123], v[88:91], v[184:187], v[120:123]
 v_mfma_f32_16x16x32_bf16 v[124:127], v[92:95], v[184:187], v[124:127]
 s_barrier
 v_add_u32 v8, 0x10000, v8
 v_add_u32 v9, 0x10000, v9
 v_add_u32 v10, 0x10000, v10
 v_add_u32 v11, 0x10000, v11
 s_waitcnt vmcnt(5)
 v_mfma_f32_16x16x32_bf16 v[112:115], v[128:131], v[188:191], v[112:115]
 ds_read_b64_tr_b16 v[240:241], v8 offset:32768
 ds_read_b64_tr_b16 v[242:243], v8 offset:40960
 buffer_load_dwordx4 v[212:215], v2, s[44:47], s60 offen offset:2048 sc1
 v_mfma_f32_16x16x32_bf16 v[116:119], v[132:135], v[188:191], v[116:119]
 ds_read_b64_tr_b16 v[244:245], v9 offset:32768
 ds_read_b64_tr_b16 v[246:247], v9 offset:40960
 v_mfma_f32_16x16x32_bf16 v[120:123], v[136:139], v[188:191], v[120:123]
 ds_read_b64_tr_b16 v[248:249], v10 offset:32768
 ds_read_b64_tr_b16 v[250:251], v10 offset:40960
 v_mfma_f32_16x16x32_bf16 v[124:127], v[140:143], v[188:191], v[124:127]
 ds_read_b64_tr_b16 v[252:253], v11 offset:32768
 ds_read_b64_tr_b16 v[254:255], v11 offset:40960
 s_waitcnt vmcnt(5)
 s_waitcnt lgkmcnt(15)
 v_mfma_f32_16x16x32_bf16 v[112:115], v[144:147], v[192:195], v[112:115]
 ds_read_b64_tr_b16 v[16:17], v8 offset:36864
 ds_read_b64_tr_b16 v[18:19], v8 offset:45056
 s_add_u32 s60, s68, 24576
 buffer_load_dwordx4 v[216:219], v2, s[44:47], s60 offen offset:0 sc1
 v_mfma_f32_16x16x32_bf16 v[116:119], v[148:151], v[192:195], v[116:119]
 ds_read_b64_tr_b16 v[20:21], v9 offset:36864
 ds_read_b64_tr_b16 v[22:23], v9 offset:45056
 v_mfma_f32_16x16x32_bf16 v[120:123], v[152:155], v[192:195], v[120:123]
 ds_read_b64_tr_b16 v[24:25], v10 offset:36864
 ds_read_b64_tr_b16 v[26:27], v10 offset:45056
 v_mfma_f32_16x16x32_bf16 v[124:127], v[156:159], v[192:195], v[124:127]
 ds_read_b64_tr_b16 v[28:29], v11 offset:36864
 ds_read_b64_tr_b16 v[30:31], v11 offset:45056
 s_waitcnt vmcnt(5)
 s_waitcnt lgkmcnt(15)
 v_mfma_f32_16x16x32_bf16 v[112:115], v[224:227], v[196:199], v[112:115]
 ds_read_b64_tr_b16 v[32:33], v8 offset:49152
 ds_read_b64_tr_b16 v[34:35], v8 offset:57344
 buffer_load_dwordx4 v[220:223], v2, s[44:47], s60 offen offset:2048 sc1
 v_mfma_f32_16x16x32_bf16 v[116:119], v[228:231], v[196:199], v[116:119]
 ds_read_b64_tr_b16 v[36:37], v9 offset:49152
 ds_read_b64_tr_b16 v[38:39], v9 offset:57344
 v_mfma_f32_16x16x32_bf16 v[120:123], v[232:235], v[196:199], v[120:123]
 ds_read_b64_tr_b16 v[40:41], v10 offset:49152
 ds_read_b64_tr_b16 v[42:43], v10 offset:57344
 v_mfma_f32_16x16x32_bf16 v[124:127], v[236:239], v[196:199], v[124:127]
 ds_read_b64_tr_b16 v[44:45], v11 offset:49152
 ds_read_b64_tr_b16 v[46:47], v11 offset:57344
 s_waitcnt vmcnt(5)
 s_waitcnt lgkmcnt(15)
 v_mfma_f32_16x16x32_bf16 v[112:115], v[240:243], v[200:203], v[112:115]
 ds_read_b64_tr_b16 v[48:49], v8 offset:53248
 ds_read_b64_tr_b16 v[50:51], v8 offset:61440
 v_mfma_f32_16x16x32_bf16 v[116:119], v[244:247], v[200:203], v[116:119]
 ds_read_b64_tr_b16 v[52:53], v9 offset:53248
 ds_read_b64_tr_b16 v[54:55], v9 offset:61440
 v_mfma_f32_16x16x32_bf16 v[120:123], v[248:251], v[200:203], v[120:123]
 ds_read_b64_tr_b16 v[56:57], v10 offset:53248
 ds_read_b64_tr_b16 v[58:59], v10 offset:61440
 v_mfma_f32_16x16x32_bf16 v[124:127], v[252:255], v[200:203], v[124:127]
 ds_read_b64_tr_b16 v[60:61], v11 offset:53248
 ds_read_b64_tr_b16 v[62:63], v11 offset:61440
 s_waitcnt vmcnt(4)
 s_waitcnt lgkmcnt(15)
 v_mfma_f32_16x16x32_bf16 v[112:115], v[16:19], v[204:207], v[112:115]
 ds_read_b64_tr_b16 v[64:65], v8 offset:0
 ds_read_b64_tr_b16 v[66:67], v8 offset:8192
 v_mfma_f32_16x16x32_bf16 v[116:119], v[20:23], v[204:207], v[116:119]
 ds_read_b64_tr_b16 v[68:69], v9 offset:0
 ds_read_b64_tr_b16 v[70:71], v9 offset:8192
 v_mfma_f32_16x16x32_bf16 v[120:123], v[24:27], v[204:207], v[120:123]
 ds_read_b64_tr_b16 v[72:73], v10 offset:0
 ds_read_b64_tr_b16 v[74:75], v10 offset:8192
 v_mfma_f32_16x16x32_bf16 v[124:127], v[28:31], v[204:207], v[124:127]
 ds_read_b64_tr_b16 v[76:77], v11 offset:0
 ds_read_b64_tr_b16 v[78:79], v11 offset:8192
 s_waitcnt vmcnt(3)
 s_waitcnt lgkmcnt(15)
 v_mfma_f32_16x16x32_bf16 v[112:115], v[32:35], v[208:211], v[112:115]
 ds_read_b64_tr_b16 v[80:81], v8 offset:4096
 ds_read_b64_tr_b16 v[82:83], v8 offset:12288
 v_mfma_f32_16x16x32_bf16 v[116:119], v[36:39], v[208:211], v[116:119]
 ds_read_b64_tr_b16 v[84:85], v9 offset:4096
 ds_read_b64_tr_b16 v[86:87], v9 offset:12288
 v_mfma_f32_16x16x32_bf16 v[120:123], v[40:43], v[208:211], v[120:123]
 ds_read_b64_tr_b16 v[88:89], v10 offset:4096
 ds_read_b64_tr_b16 v[90:91], v10 offset:12288
 v_mfma_f32_16x16x32_bf16 v[124:127], v[44:47], v[208:211], v[124:127]
 ds_read_b64_tr_b16 v[92:93], v11 offset:4096
 ds_read_b64_tr_b16 v[94:95], v11 offset:12288
 s_waitcnt vmcnt(2)
 s_waitcnt lgkmcnt(15)
 v_mfma_f32_16x16x32_bf16 v[112:115], v[48:51], v[212:215], v[112:115]
 v_mfma_f32_16x16x32_bf16 v[116:119], v[52:55], v[212:215], v[116:119]
 v_mfma_f32_16x16x32_bf16 v[120:123], v[56:59], v[212:215], v[120:123]
 v_mfma_f32_16x16x32_bf16 v[124:127], v[60:63], v[212:215], v[124:127]
 s_waitcnt vmcnt(1)
 s_waitcnt lgkmcnt(14)
 v_mfma_f32_16x16x32_bf16 v[112:115], v[64:67], v[216:219], v[112:115]
 s_waitcnt lgkmcnt(12)
 v_mfma_f32_16x16x32_bf16 v[116:119], v[68:71], v[216:219], v[116:119]
 s_waitcnt lgkmcnt(10)
 v_mfma_f32_16x16x32_bf16 v[120:123], v[72:75], v[216:219], v[120:123]
 s_waitcnt lgkmcnt(8)
 v_mfma_f32_16x16x32_bf16 v[124:127], v[76:79], v[216:219], v[124:127]
 s_waitcnt vmcnt(0)
 s_waitcnt lgkmcnt(6)
 v_mfma_f32_16x16x32_bf16 v[112:115], v[80:83], v[220:223], v[112:115]
 s_waitcnt lgkmcnt(4)
 v_mfma_f32_16x16x32_bf16 v[116:119], v[84:87], v[220:223], v[116:119]
 s_waitcnt lgkmcnt(2)
 v_mfma_f32_16x16x32_bf16 v[120:123], v[88:91], v[220:223], v[120:123]
 s_waitcnt lgkmcnt(0)
 v_mfma_f32_16x16x32_bf16 v[124:127], v[92:95], v[220:223], v[124:127]
 s_nop 1
 ds_write_b128 v14, v[112:115]
 s_nop 0
 ds_write_b128 v3, v[116:119]
 s_nop 0
 ds_write_b128 v4, v[120:123]
 s_nop 0
 ds_write_b128 v5, v[124:127]
 s_waitcnt lgkmcnt(0)
 s_barrier
 ds_read_b128 v[112:115], v15 offset:0
 ds_read_b128 v[120:123], v15 offset:16384
 ds_read_b128 v[116:119], v7 offset:0
 ds_read_b128 v[124:127], v7 offset:16384
 s_mov_b32 s76, 0xbfb8aa3b
 s_mov_b32 s77, s76
 s_waitcnt lgkmcnt(2)
 v_pk_add_f32 v[112:113], v[112:113], v[120:121]
 v_pk_add_f32 v[114:115], v[114:115], v[122:123]
 v_pk_mul_f32 v[48:49], v[112:113], s[76:77]
 v_pk_mul_f32 v[50:51], v[114:115], s[76:77]
 v_exp_f32 v48, v48
 v_exp_f32 v49, v49
 v_exp_f32 v50, v50
 v_exp_f32 v51, v51
 s_waitcnt lgkmcnt(0)
 v_pk_add_f32 v[116:117], v[116:117], v[124:125]
 v_pk_add_f32 v[118:119], v[118:119], v[126:127]
 v_pk_mul_f32 v[52:53], v[116:117], s[76:77]
 v_pk_mul_f32 v[54:55], v[118:119], s[76:77]
 v_exp_f32 v52, v52
 v_exp_f32 v53, v53
 v_exp_f32 v54, v54
 v_exp_f32 v55, v55
 v_pk_add_f32 v[48:49], v[48:49], 1.0 op_sel_hi:[1,0]
 v_pk_add_f32 v[50:51], v[50:51], 1.0 op_sel_hi:[1,0]
 v_pk_add_f32 v[52:53], v[52:53], 1.0 op_sel_hi:[1,0]
 v_pk_add_f32 v[54:55], v[54:55], 1.0 op_sel_hi:[1,0]
 v_rcp_f32 v48, v48
 v_rcp_f32 v49, v49
 v_rcp_f32 v50, v50
 v_rcp_f32 v51, v51
 v_rcp_f32 v52, v52
 v_rcp_f32 v53, v53
 v_rcp_f32 v54, v54
 v_rcp_f32 v55, v55
 v_pk_mul_f32 v[96:97], v[96:97], v[112:113]
 v_pk_mul_f32 v[98:99], v[98:99], v[114:115]
 v_pk_mul_f32 v[100:101], v[100:101], v[116:117]
 v_pk_mul_f32 v[102:103], v[102:103], v[118:119]
 v_pk_fma_f32 v[104:105], v[48:49], v[96:97], v[104:105]
 v_pk_fma_f32 v[106:107], v[50:51], v[98:99], v[106:107]
 v_pk_fma_f32 v[108:109], v[52:53], v[100:101], v[108:109]
 v_pk_fma_f32 v[110:111], v[54:55], v[102:103], v[110:111]
 v_cvt_pk_bf16_f32 v112, v104, v105
 v_cvt_pk_bf16_f32 v113, v106, v107
 v_cvt_pk_bf16_f32 v114, v108, v109
 v_cvt_pk_bf16_f32 v115, v110, v111
 buffer_store_dwordx4 v[112:115], v160, s[36:39], s79 offen sc1
 s_endpgm
L_exit:
 s_endpgm
L_hpre:
 s_mov_b32 s22, 1835008
 s_mov_b32 s23, 0x20000
 s_mov_b32 s14, 1572864
 s_mov_b32 s15, 0x20000
 s_lshl_b32 s62, s48, 3
 s_add_u32 s62, s62, s50
 s_mul_i32 s63, s62, 6144
 s_mul_i32 s62, s62, 7168
 v_min_u32 v18, 47, v1
 v_lshlrev_b32 v18, 7, v18
 v_and_b32 v19, 15, v1
 v_min_u32 v19, 13, v19
 v_bfe_u32 v20, v1, 4, 1
 v_mul_u32_u24 v20, 3584, v20
 v_lshl_add_u32 v19, v19, 7, v20
 s_waitcnt lgkmcnt(0)
 buffer_load_dword v13, v19, s[20:23], s62 offen offset:1792
 s_barrier
 v_and_b32 v18, 7, v1
 v_bfe_u32 v20, v1, 3, 1
 v_mul_u32_u24 v20, 3072, v20
 v_lshl_add_u32 v18, v18, 7, v20
 s_mov_b64 exec, 0xffff
 buffer_load_dword v13, v18, s[12:15], s63 offen offset:1024
 s_barrier
 buffer_load_dword v13, v18, s[12:15], s63 offen offset:2048
 s_barrier
 buffer_load_dword v13, v18, s[12:15], s63 offen
 s_mov_b64 exec, -1
 s_barrier
 buffer_load_dword v13, v19, s[20:23], s62 offen
 s_branch L_x0
L_progh:
 v_lshrrev_b32 v10, 4, v1
 v_and_b32 v11, 15, v1
 v_lshlrev_b32 v10, 12, v10
 v_lshl_add_u32 v10, v11, 7, v10
 v_xor_b32 v11, s48, v11
 v_and_b32 v11, 1, v11
 v_lshl_add_u32 v10, v11, 11, v10
 s_lshr_b32 s62, s48, 1
 s_lshl_b32 s62, s62, 19
 s_and_b32 s63, s48, 1
 s_xor_b32 s63, s63, 1
 s_lshl_b32 s63, s63, 18
 s_add_u32 s62, s62, s63
 s_lshl_b32 s63, s50, 14
 s_add_u32 s62, s62, s63
 s_xor_b32 s63, s62, 0
 buffer_load_dword v7, v10, s[24:27], s63 offen
 s_xor_b32 s63, s62, 131072
 buffer_load_dword v7, v10, s[24:27], s63 offen
 s_xor_b32 s63, s62, 262144
 buffer_load_dword v7, v10, s[24:27], s63 offen
 s_cmp_ge_u32 s50, 4
 s_cbranch_scc1 L_hq_27
 s_xor_b32 s63, s62, 393216
 buffer_load_dword v7, v10, s[24:27], s63 offen
L_hq_27:
 s_waitcnt vmcnt(10)
 v_dot2c_f32_bf16 v96, s66, v48
 v_lshlrev_b32 v128, 16, v48
 v_dot2c_f32_bf16 v97, v48, v48
 v_and_b32 v129, v104, v48
 v_dot2c_f32_bf16 v98, s66, v49
 v_lshlrev_b32 v130, 16, v49
 v_dot2c_f32_bf16 v99, v49, v49
 v_and_b32 v131, v104, v49
 v_dot2c_f32_bf16 v96, s66, v50
 v_lshlrev_b32 v132, 16, v50
 v_dot2c_f32_bf16 v97, v50, v50
 v_and_b32 v133, v104, v50
 v_dot2c_f32_bf16 v98, s66, v51
 v_lshlrev_b32 v134, 16, v51
 v_dot2c_f32_bf16 v99, v51, v51
 v_and_b32 v135, v104, v51
 s_waitcnt vmcnt(9)
 v_dot2c_f32_bf16 v96, s66, v52
 v_lshlrev_b32 v136, 16, v52
 v_dot2c_f32_bf16 v97, v52, v52
 v_and_b32 v137, v104, v52
 v_dot2c_f32_bf16 v98, s66, v53
 v_lshlrev_b32 v138, 16, v53
 v_dot2c_f32_bf16 v99, v53, v53
 v_and_b32 v139, v104, v53
 v_dot2c_f32_bf16 v96, s66, v54
 v_lshlrev_b32 v140, 16, v54
 v_dot2c_f32_bf16 v97, v54, v54
 v_and_b32 v141, v104, v54
 v_dot2c_f32_bf16 v98, s66, v55
 v_lshlrev_b32 v142, 16, v55
 v_dot2c_f32_bf16 v99, v55, v55
 v_and_b32 v143, v104, v55
 s_waitcnt vmcnt(8)
 v_dot2c_f32_bf16 v96, s66, v56
 v_lshlrev_b32 v144, 16, v56
 v_dot2c_f32_bf16 v97, v56, v56
 v_and_b32 v145, v104, v56
 v_dot2c_f32_bf16 v98, s66, v57
 v_lshlrev_b32 v146, 16, v57
 v_dot2c_f32_bf16 v99, v57, v57
 v_and_b32 v147, v104, v57
 v_dot2c_f32_bf16 v96, s66, v58
 v_lshlrev_b32 v148, 16, v58
 v_dot2c_f32_bf16 v97, v58, v58
 v_and_b32 v149, v104, v58
 v_dot2c_f32_bf16 v98, s66, v59
 v_lshlrev_b32 v150, 16, v59
 v_dot2c_f32_bf16 v99, v59, v59
 v_and_b32 v151, v104, v59
 s_waitcnt vmcnt(7)
 v_dot2c_f32_bf16 v96, s66, v60
 v_lshlrev_b32 v152, 16, v60
 v_dot2c_f32_bf16 v97, v60, v60
 v_and_b32 v153, v104, v60
 v_dot2c_f32_bf16 v98, s66, v61
 v_lshlrev_b32 v154, 16, v61
 v_dot2c_f32_bf16 v99, v61, v61
 v_and_b32 v155, v104, v61
 v_dot2c_f32_bf16 v96, s66, v62
 v_lshlrev_b32 v156, 16, v62
 v_dot2c_f32_bf16 v97, v62, v62
 v_and_b32 v157, v104, v62
 v_dot2c_f32_bf16 v98, s66, v63
 v_lshlrev_b32 v158, 16, v63
 v_dot2c_f32_bf16 v99, v63, v63
 v_and_b32 v159, v104, v63
 s_waitcnt vmcnt(6)
 v_dot2c_f32_bf16 v96, s66, v64
 v_lshlrev_b32 v160, 16, v64
 v_dot2c_f32_bf16 v97, v64, v64
 v_and_b32 v161, v104, v64
 v_dot2c_f32_bf16 v98, s66, v65
 v_lshlrev_b32 v162, 16, v65
 v_dot2c_f32_bf16 v99, v65, v65
 v_and_b32 v163, v104, v65
 v_dot2c_f32_bf16 v96, s66, v66
 v_lshlrev_b32 v164, 16, v66
 v_dot2c_f32_bf16 v97, v66, v66
 v_and_b32 v165, v104, v66
 v_dot2c_f32_bf16 v98, s66, v67
 v_lshlrev_b32 v166, 16, v67
 v_dot2c_f32_bf16 v99, v67, v67
 v_and_b32 v167, v104, v67
 s_waitcnt vmcnt(5)
 v_dot2c_f32_bf16 v96, s66, v68
 v_lshlrev_b32 v168, 16, v68
 v_dot2c_f32_bf16 v97, v68, v68
 v_and_b32 v169, v104, v68
 v_dot2c_f32_bf16 v98, s66, v69
 v_lshlrev_b32 v170, 16, v69
 v_dot2c_f32_bf16 v99, v69, v69
 v_and_b32 v171, v104, v69
 v_dot2c_f32_bf16 v96, s66, v70
 v_lshlrev_b32 v172, 16, v70
 v_dot2c_f32_bf16 v97, v70, v70
 v_and_b32 v173, v104, v70
 v_dot2c_f32_bf16 v98, s66, v71
 v_lshlrev_b32 v174, 16, v71
 v_dot2c_f32_bf16 v99, v71, v71
 v_and_b32 v175, v104, v71
 s_waitcnt vmcnt(4)
 v_dot2c_f32_bf16 v96, s66, v72
 v_lshlrev_b32 v176, 16, v72
 v_dot2c_f32_bf16 v97, v72, v72
 v_and_b32 v177, v104, v72
 v_dot2c_f32_bf16 v98, s66, v73
 v_lshlrev_b32 v178, 16, v73
 v_dot2c_f32_bf16 v99, v73, v73
 v_and_b32 v179, v104, v73
 v_dot2c_f32_bf16 v96, s66, v74
 v_lshlrev_b32 v180, 16, v74
 v_dot2c_f32_bf16 v97, v74, v74
 v_and_b32 v181, v104, v74
 v_dot2c_f32_bf16 v98, s66, v75
 v_lshlrev_b32 v182, 16, v75
 v_dot2c_f32_bf16 v99, v75, v75
 v_and_b32 v183, v104, v75
 s_waitcnt vmcnt(3)
 v_dot2c_f32_bf16 v96, s66, v76
 v_lshlrev_b32 v184, 16, v76
 v_dot2c_f32_bf16 v97, v76, v76
 v_and_b32 v185, v104, v76
 v_dot2c_f32_bf16 v98, s66, v77
 v_lshlrev_b32 v186, 16, v77
 v_dot2c_f32_bf16 v99, v77, v77
 v_and_b32 v187, v104, v77
 v_dot2c_f32_bf16 v96, s66, v78
 v_lshlrev_b32 v188, 16, v78
 v_dot2c_f32_bf16 v97, v78, v78
 v_and_b32 v189, v104, v78
 v_dot2c_f32_bf16 v98, s66, v79
 v_lshlrev_b32 v190, 16, v79
 v_dot2c_f32_bf16 v99, v79, v79
 v_and_b32 v191, v104, v79
 s_add_u32 m0, s54, 65536
 s_add_u32 s60, s57, 1024
 buffer_load_dwordx4 v4, s[12:15], s60 offen lds
 s_add_u32 m0, s54, 73728
 s_add_u32 s60, s57, 197632
 buffer_load_dwordx4 v4, s[12:15], s60 offen lds
 s_add_u32 m0, s54, 81920
 s_add_u32 s60, s57, 394240
 buffer_load_dwordx4 v4, s[12:15], s60 offen lds
 s_add_u32 m0, s54, 90112
 s_add_u32 s60, s57, 590848
 buffer_load_dwordx4 v4, s[12:15], s60 offen lds
 v_pk_add_f32 v[96:97], v[96:97], v[98:99]
 s_nop 1
 v_add_f32_dpp v96, v96, v96 quad_perm:[1,0,3,2] row_mask:0xf bank_mask:0xf
 v_add_f32_dpp v97, v97, v97 quad_perm:[1,0,3,2] row_mask:0xf bank_mask:0xf
 s_nop 0
 v_add_f32_dpp v96, v96, v96 quad_perm:[2,3,0,1] row_mask:0xf bank_mask:0xf
 v_add_f32_dpp v97, v97, v97 quad_perm:[2,3,0,1] row_mask:0xf bank_mask:0xf
 s_nop 0
 v_add_f32_dpp v96, v96, v96 row_half_mirror row_mask:0xf bank_mask:0xf
 v_add_f32_dpp v97, v97, v97 row_half_mirror row_mask:0xf bank_mask:0xf
 v_mul_f32 v96, 0xbb000000, v96
 v_mul_f32 v97, 0x3b000000, v97
 v_fma_f32 v97, -v96, v96, v97
 v_max_f32 v97, 0, v97
 v_add_f32 v97, 0x3727c5ac, v97
 v_rsq_f32 v100, v97
 s_nop 0
 v_mul_f32 v102, v96, v100
 v_mov_b32 v101, v100
 v_mov_b32 v103, v102
 v_pk_fma_f32 v[128:129], v[128:129], v[100:101], v[102:103]
 v_pk_fma_f32 v[130:131], v[130:131], v[100:101], v[102:103]
 v_pk_fma_f32 v[132:133], v[132:133], v[100:101], v[102:103]
 v_pk_fma_f32 v[134:135], v[134:135], v[100:101], v[102:103]
 v_cvt_pk_bf16_f32 v48, v128, v129
 v_cvt_pk_bf16_f32 v49, v130, v131
 v_cvt_pk_bf16_f32 v50, v132, v133
 v_cvt_pk_bf16_f32 v51, v134, v135
 ds_write_b128 v16, v[48:51] offset:0
 v_pk_fma_f32 v[136:137], v[136:137], v[100:101], v[102:103]
 v_pk_fma_f32 v[138:139], v[138:139], v[100:101], v[102:103]
 v_pk_fma_f32 v[140:141], v[140:141], v[100:101], v[102:103]
 v_pk_fma_f32 v[142:143], v[142:143], v[100:101], v[102:103]
 v_cvt_pk_bf16_f32 v52, v136, v137
 v_cvt_pk_bf16_f32 v53, v138, v139
 v_cvt_pk_bf16_f32 v54, v140, v141
 v_cvt_pk_bf16_f32 v55, v142, v143
 ds_write_b128 v16, v[52:55] offset:8192
 v_pk_fma_f32 v[144:145], v[144:145], v[100:101], v[102:103]
 v_pk_fma_f32 v[146:147], v[146:147], v[100:101], v[102:103]
 v_pk_fma_f32 v[148:149], v[148:149], v[100:101], v[102:103]
 v_pk_fma_f32 v[150:151], v[150:151], v[100:101], v[102:103]
 v_cvt_pk_bf16_f32 v56, v144, v145
 v_cvt_pk_bf16_f32 v57, v146, v147
 v_cvt_pk_bf16_f32 v58, v148, v149
 v_cvt_pk_bf16_f32 v59, v150, v151
 ds_write_b128 v16, v[56:59] offset:16384
 v_pk_fma_f32 v[152:153], v[152:153], v[100:101], v[102:103]
 v_pk_fma_f32 v[154:155], v[154:155], v[100:101], v[102:103]
 v_pk_fma_f32 v[156:157], v[156:157], v[100:101], v[102:103]
 v_pk_fma_f32 v[158:159], v[158:159], v[100:101], v[102:103]
 v_cvt_pk_bf16_f32 v60, v152, v153
 v_cvt_pk_bf16_f32 v61, v154, v155
 v_cvt_pk_bf16_f32 v62, v156, v157
 v_cvt_pk_bf16_f32 v63, v158, v159
 ds_write_b128 v16, v[60:63] offset:24576
 v_pk_fma_f32 v[160:161], v[160:161], v[100:101], v[102:103]
 v_pk_fma_f32 v[162:163], v[162:163], v[100:101], v[102:103]
 v_pk_fma_f32 v[164:165], v[164:165], v[100:101], v[102:103]
 v_pk_fma_f32 v[166:167], v[166:167], v[100:101], v[102:103]
 v_cvt_pk_bf16_f32 v64, v160, v161
 v_cvt_pk_bf16_f32 v65, v162, v163
 v_cvt_pk_bf16_f32 v66, v164, v165
 v_cvt_pk_bf16_f32 v67, v166, v167
 ds_write_b128 v16, v[64:67] offset:32768
 v_pk_fma_f32 v[168:169], v[168:169], v[100:101], v[102:103]
 v_pk_fma_f32 v[170:171], v[170:171], v[100:101], v[102:103]
 v_pk_fma_f32 v[172:173], v[172:173], v[100:101], v[102:103]
 v_pk_fma_f32 v[174:175], v[174:175], v[100:101], v[102:103]
 v_cvt_pk_bf16_f32 v68, v168, v169
 v_cvt_pk_bf16_f32 v69, v170, v171
 v_cvt_pk_bf16_f32 v70, v172, v173
 v_cvt_pk_bf16_f32 v71, v174, v175
 ds_write_b128 v16, v[68:71] offset:40960
 v_pk_fma_f32 v[176:177], v[176:177], v[100:101], v[102:103]
 v_pk_fma_f32 v[178:179], v[178:179], v[100:101], v[102:103]
 v_pk_fma_f32 v[180:181], v[180:181], v[100:101], v[102:103]
 v_pk_fma_f32 v[182:183], v[182:183], v[100:101], v[102:103]
 v_cvt_pk_bf16_f32 v72, v176, v177
 v_cvt_pk_bf16_f32 v73, v178, v179
 v_cvt_pk_bf16_f32 v74, v180, v181
 v_cvt_pk_bf16_f32 v75, v182, v183
 ds_write_b128 v16, v[72:75] offset:49152
 v_pk_fma_f32 v[184:185], v[184:185], v[100:101], v[102:103]
 v_pk_fma_f32 v[186:187], v[186:187], v[100:101], v[102:103]
 v_pk_fma_f32 v[188:189], v[188:189], v[100:101], v[102:103]
 v_pk_fma_f32 v[190:191], v[190:191], v[100:101], v[102:103]
 v_cvt_pk_bf16_f32 v76, v184, v185
 v_cvt_pk_bf16_f32 v77, v186, v187
 v_cvt_pk_bf16_f32 v78, v188, v189
 v_cvt_pk_bf16_f32 v79, v190, v191
 ds_write_b128 v16, v[76:79] offset:57344
 s_cmp_lg_u32 s51, 0
 s_cbranch_scc1 L_o_28
L_o_28:
 s_waitcnt vmcnt(0)
 s_waitcnt lgkmcnt(0)
 s_barrier
 s_add_u32 m0, s54, 98304
 s_add_u32 s60, s73, 1024
 buffer_load_dwordx4 v4, s[12:15], s60 offen lds
 s_add_u32 m0, s54, 106496
 s_add_u32 s60, s73, 197632
 buffer_load_dwordx4 v4, s[12:15], s60 offen lds
 s_add_u32 m0, s54, 114688
 s_add_u32 s60, s73, 394240
 buffer_load_dwordx4 v4, s[12:15], s60 offen lds
 s_add_u32 m0, s54, 122880
 s_add_u32 s60, s73, 590848
 buffer_load_dwordx4 v4, s[12:15], s60 offen lds
 v_add_u32 v8, 0x10000, v8
 v_add_u32 v9, 0x10000, v9
 ds_read_b64_tr_b16 v[48:49], v8 offset:0
 ds_read_b64_tr_b16 v[50:51], v9 offset:0
 ds_read_b128 v[128:131], v14 offset:0
 ds_read_b128 v[192:195], v14 offset:2048
 ds_read_b64_tr_b16 v[52:53], v8 offset:4096
 ds_read_b64_tr_b16 v[54:55], v9 offset:4096
 ds_read_b128 v[132:135], v15 offset:0
 ds_read_b128 v[196:199], v15 offset:2048
 ds_read_b64_tr_b16 v[56:57], v8 offset:8192
 ds_read_b64_tr_b16 v[58:59], v9 offset:8192
 ds_read_b128 v[136:139], v14 offset:8192
 ds_read_b128 v[200:203], v14 offset:10240
 ds_read_b64_tr_b16 v[60:61], v8 offset:12288
 ds_read_b64_tr_b16 v[62:63], v9 offset:12288
 ds_read_b128 v[140:143], v15 offset:8192
 ds_read_b128 v[204:207], v15 offset:10240
 s_waitcnt lgkmcnt(12)
 v_mfma_f32_16x16x32_bf16 v[96:99], v[48:51], v[128:131], 0
 ds_read_b64_tr_b16 v[64:65], v8 offset:16384
 ds_read_b64_tr_b16 v[66:67], v9 offset:16384
 v_mfma_f32_16x16x32_bf16 v[100:103], v[48:51], v[192:195], 0
 ds_read_b128 v[144:147], v14 offset:16384
 ds_read_b128 v[208:211], v14 offset:18432
 s_add_u32 m0, s54, 131072
 s_add_u32 s60, s57, 2048
 buffer_load_dwordx4 v4, s[12:15], s60 offen lds
 s_waitcnt lgkmcnt(12)
 v_mfma_f32_16x16x32_bf16 v[96:99], v[52:55], v[132:135], v[96:99]
 ds_read_b64_tr_b16 v[68:69], v8 offset:20480
 ds_read_b64_tr_b16 v[70:71], v9 offset:20480
 v_mfma_f32_16x16x32_bf16 v[100:103], v[52:55], v[196:199], v[100:103]
 ds_read_b128 v[148:151], v15 offset:16384
 ds_read_b128 v[212:215], v15 offset:18432
 s_add_u32 m0, s54, 139264
 s_add_u32 s60, s57, 198656
 buffer_load_dwordx4 v4, s[12:15], s60 offen lds
 s_waitcnt lgkmcnt(12)
 v_mfma_f32_16x16x32_bf16 v[96:99], v[56:59], v[136:139], v[96:99]
 ds_read_b64_tr_b16 v[72:73], v8 offset:24576
 ds_read_b64_tr_b16 v[74:75], v9 offset:24576
 v_mfma_f32_16x16x32_bf16 v[100:103], v[56:59], v[200:203], v[100:103]
 ds_read_b128 v[152:155], v14 offset:24576
 ds_read_b128 v[216:219], v14 offset:26624
 s_add_u32 m0, s54, 147456
 s_add_u32 s60, s57, 395264
 buffer_load_dwordx4 v4, s[12:15], s60 offen lds
 s_waitcnt lgkmcnt(12)
 v_mfma_f32_16x16x32_bf16 v[96:99], v[60:63], v[140:143], v[96:99]
 ds_read_b64_tr_b16 v[76:77], v8 offset:28672
 ds_read_b64_tr_b16 v[78:79], v9 offset:28672
 v_mfma_f32_16x16x32_bf16 v[100:103], v[60:63], v[204:207], v[100:103]
 ds_read_b128 v[156:159], v15 offset:24576
 ds_read_b128 v[220:223], v15 offset:26624
 s_add_u32 m0, s54, 155648
 s_add_u32 s60, s57, 591872
 buffer_load_dwordx4 v4, s[12:15], s60 offen lds
 s_waitcnt vmcnt(4)
 s_waitcnt lgkmcnt(0)
 s_barrier
 v_mfma_f32_16x16x32_bf16 v[96:99], v[64:67], v[144:147], v[96:99]
 ds_read_b64_tr_b16 v[48:49], v8 offset:32768
 ds_read_b64_tr_b16 v[50:51], v9 offset:32768
 v_mfma_f32_16x16x32_bf16 v[100:103], v[64:67], v[208:211], v[100:103]
 ds_read_b128 v[160:163], v14 offset:32768
 ds_read_b128 v[224:227], v14 offset:34816
 s_add_u32 m0, s54, 65536
 s_add_u32 s60, s73, 2048
 buffer_load_dwordx4 v4, s[12:15], s60 offen lds
 v_mfma_f32_16x16x32_bf16 v[96:99], v[68:71], v[148:151], v[96:99]
 ds_read_b64_tr_b16 v[52:53], v8 offset:36864
 ds_read_b64_tr_b16 v[54:55], v9 offset:36864
 v_mfma_f32_16x16x32_bf16 v[100:103], v[68:71], v[212:215], v[100:103]
 ds_read_b128 v[164:167], v15 offset:32768
 ds_read_b128 v[228:231], v15 offset:34816
 s_add_u32 m0, s54, 73728
 s_add_u32 s60, s73, 198656
 buffer_load_dwordx4 v4, s[12:15], s60 offen lds
 v_mfma_f32_16x16x32_bf16 v[96:99], v[72:75], v[152:155], v[96:99]
 ds_read_b64_tr_b16 v[56:57], v8 offset:40960
 ds_read_b64_tr_b16 v[58:59], v9 offset:40960
 v_mfma_f32_16x16x32_bf16 v[100:103], v[72:75], v[216:219], v[100:103]
 ds_read_b128 v[168:171], v14 offset:40960
 ds_read_b128 v[232:235], v14 offset:43008
 s_add_u32 m0, s54, 81920
 s_add_u32 s60, s73, 395264
 buffer_load_dwordx4 v4, s[12:15], s60 offen lds
 v_mfma_f32_16x16x32_bf16 v[96:99], v[76:79], v[156:159], v[96:99]
 ds_read_b64_tr_b16 v[60:61], v8 offset:45056
 ds_read_b64_tr_b16 v[62:63], v9 offset:45056
 v_mfma_f32_16x16x32_bf16 v[100:103], v[76:79], v[220:223], v[100:103]
 ds_read_b128 v[172:175], v15 offset:40960
 ds_read_b128 v[236:239], v15 offset:43008
 s_add_u32 m0, s54, 90112
 s_add_u32 s60, s73, 591872
 buffer_load_dwordx4 v4, s[12:15], s60 offen lds
 s_waitcnt lgkmcnt(12)
 v_mfma_f32_16x16x32_bf16 v[96:99], v[48:51], v[160:163], v[96:99]
 ds_read_b64_tr_b16 v[64:65], v8 offset:49152
 ds_read_b64_tr_b16 v[66:67], v9 offset:49152
 v_mfma_f32_16x16x32_bf16 v[100:103], v[48:51], v[224:227], v[100:103]
 ds_read_b128 v[176:179], v14 offset:49152
 ds_read_b128 v[240:243], v14 offset:51200
 s_waitcnt lgkmcnt(12)
 v_mfma_f32_16x16x32_bf16 v[96:99], v[52:55], v[164:167], v[96:99]
 ds_read_b64_tr_b16 v[68:69], v8 offset:53248
 ds_read_b64_tr_b16 v[70:71], v9 offset:53248
 v_mfma_f32_16x16x32_bf16 v[100:103], v[52:55], v[228:231], v[100:103]
 ds_read_b128 v[180:183], v15 offset:49152
 ds_read_b128 v[244:247], v15 offset:51200
 s_waitcnt lgkmcnt(12)
 v_mfma_f32_16x16x32_bf16 v[96:99], v[56:59], v[168:171], v[96:99]
 ds_read_b64_tr_b16 v[72:73], v8 offset:57344
 ds_read_b64_tr_b16 v[74:75], v9 offset:57344
 v_mfma_f32_16x16x32_bf16 v[100:103], v[56:59], v[232:235], v[100:103]
 ds_read_b128 v[184:187], v14 offset:57344
 ds_read_b128 v[248:251], v14 offset:59392
 s_waitcnt lgkmcnt(12)
 v_mfma_f32_16x16x32_bf16 v[96:99], v[60:63], v[172:175], v[96:99]
 ds_read_b64_tr_b16 v[76:77], v8 offset:61440
 ds_read_b64_tr_b16 v[78:79], v9 offset:61440
 v_mfma_f32_16x16x32_bf16 v[100:103], v[60:63], v[236:239], v[100:103]
 ds_read_b128 v[188:191], v15 offset:57344
 ds_read_b128 v[252:255], v15 offset:59392
 buffer_load_dwordx2 v[12:13], off, s[40:43], 0 sc1
 s_waitcnt vmcnt(5)
 s_waitcnt lgkmcnt(0)
 s_barrier
 v_add_u32 v8, 0x10000, v8
 v_add_u32 v9, 0x10000, v9
 v_mfma_f32_16x16x32_bf16 v[96:99], v[64:67], v[176:179], v[96:99]
 ds_read_b64_tr_b16 v[48:49], v8 offset:0
 v_mfma_f32_16x16x32_bf16 v[100:103], v[64:67], v[240:243], v[100:103]
 ds_read_b64_tr_b16 v[50:51], v9 offset:0
 v_mfma_f32_16x16x32_bf16 v[96:99], v[68:71], v[180:183], v[96:99]
 ds_read_b64_tr_b16 v[52:53], v8 offset:4096
 v_mfma_f32_16x16x32_bf16 v[100:103], v[68:71], v[244:247], v[100:103]
 ds_read_b64_tr_b16 v[54:55], v9 offset:4096
 s_add_u32 m0, s54, 0
 s_add_u32 s60, s57, 0
 buffer_load_dwordx4 v4, s[12:15], s60 offen lds
 v_mfma_f32_16x16x32_bf16 v[96:99], v[72:75], v[184:187], v[96:99]
 ds_read_b64_tr_b16 v[56:57], v8 offset:8192
 v_mfma_f32_16x16x32_bf16 v[100:103], v[72:75], v[248:251], v[100:103]
 ds_read_b64_tr_b16 v[58:59], v9 offset:8192
 v_mfma_f32_16x16x32_bf16 v[96:99], v[76:79], v[188:191], v[96:99]
 ds_read_b64_tr_b16 v[60:61], v8 offset:12288
 v_mfma_f32_16x16x32_bf16 v[100:103], v[76:79], v[252:255], v[100:103]
 ds_read_b64_tr_b16 v[62:63], v9 offset:12288
 s_add_u32 m0, s54, 8192
 s_add_u32 s60, s57, 196608
 buffer_load_dwordx4 v4, s[12:15], s60 offen lds
 s_waitcnt lgkmcnt(6)
 v_mfma_f32_16x16x32_bf16 v[104:107], v[128:131], v[48:51], 0
 ds_read_b64_tr_b16 v[64:65], v8 offset:16384
 v_cvt_pk_bf16_f32 v80, v96, v97
 v_cvt_pk_bf16_f32 v81, v98, v99
 v_mfma_f32_16x16x32_bf16 v[108:111], v[192:195], v[48:51], 0
 ds_read_b64_tr_b16 v[66:67], v9 offset:16384
 v_cvt_pk_bf16_f32 v82, v100, v101
 v_cvt_pk_bf16_f32 v83, v102, v103
 s_waitcnt lgkmcnt(6)
 v_mfma_f32_16x16x32_bf16 v[104:107], v[132:135], v[52:55], v[104:107]
 ds_read_b64_tr_b16 v[68:69], v8 offset:20480
 v_mfma_f32_16x16x32_bf16 v[108:111], v[196:199], v[52:55], v[108:111]
 ds_read_b64_tr_b16 v[70:71], v9 offset:20480
 s_add_u32 m0, s54, 16384
 s_add_u32 s60, s57, 393216
 buffer_load_dwordx4 v4, s[12:15], s60 offen lds
 s_waitcnt lgkmcnt(6)
 v_mfma_f32_16x16x32_bf16 v[104:107], v[136:139], v[56:59], v[104:107]
 ds_read_b64_tr_b16 v[72:73], v8 offset:24576
 v_mfma_f32_16x16x32_bf16 v[108:111], v[200:203], v[56:59], v[108:111]
 ds_read_b64_tr_b16 v[74:75], v9 offset:24576
 s_waitcnt lgkmcnt(6)
 v_mfma_f32_16x16x32_bf16 v[104:107], v[140:143], v[60:63], v[104:107]
 ds_read_b64_tr_b16 v[76:77], v8 offset:28672
 v_mfma_f32_16x16x32_bf16 v[108:111], v[204:207], v[60:63], v[108:111]
 ds_read_b64_tr_b16 v[78:79], v9 offset:28672
 s_add_u32 m0, s54, 24576
 s_add_u32 s60, s57, 589824
 buffer_load_dwordx4 v4, s[12:15], s60 offen lds
 s_waitcnt vmcnt(5)
 s_waitcnt lgkmcnt(0)
 s_barrier
 v_add_u32 v8, 0xffff0000, v8
 v_add_u32 v9, 0xffff0000, v9
 v_mfma_f32_16x16x32_bf16 v[104:107], v[144:147], v[64:67], v[104:107]
 ds_read_b64_tr_b16 v[48:49], v8 offset:0
 v_mfma_f32_16x16x32_bf16 v[108:111], v[208:211], v[64:67], v[108:111]
 ds_read_b64_tr_b16 v[50:51], v9 offset:0
 v_mfma_f32_16x16x32_bf16 v[104:107], v[148:151], v[68:71], v[104:107]
 ds_read_b64_tr_b16 v[52:53], v8 offset:4096
 v_mfma_f32_16x16x32_bf16 v[108:111], v[212:215], v[68:71], v[108:111]
 ds_read_b64_tr_b16 v[54:55], v9 offset:4096
 s_add_u32 m0, s54, 32768
 s_add_u32 s60, s73, 0
 buffer_load_dwordx4 v4, s[12:15], s60 offen lds
 v_mfma_f32_16x16x32_bf16 v[104:107], v[152:155], v[72:75], v[104:107]
 ds_read_b64_tr_b16 v[56:57], v8 offset:8192
 v_mfma_f32_16x16x32_bf16 v[108:111], v[216:219], v[72:75], v[108:111]
 ds_read_b64_tr_b16 v[58:59], v9 offset:8192
 v_mfma_f32_16x16x32_bf16 v[104:107], v[156:159], v[76:79], v[104:107]
 ds_read_b64_tr_b16 v[60:61], v8 offset:12288
 v_mfma_f32_16x16x32_bf16 v[108:111], v[220:223], v[76:79], v[108:111]
 ds_read_b64_tr_b16 v[62:63], v9 offset:12288
 s_add_u32 m0, s54, 40960
 s_add_u32 s60, s73, 196608
 buffer_load_dwordx4 v4, s[12:15], s60 offen lds
 s_waitcnt lgkmcnt(6)
 v_mfma_f32_16x16x32_bf16 v[104:107], v[160:163], v[48:51], v[104:107]
 ds_read_b64_tr_b16 v[64:65], v8 offset:16384
 v_mfma_f32_16x16x32_bf16 v[108:111], v[224:227], v[48:51], v[108:111]
 ds_read_b64_tr_b16 v[66:67], v9 offset:16384
 s_waitcnt lgkmcnt(6)
 v_mfma_f32_16x16x32_bf16 v[104:107], v[164:167], v[52:55], v[104:107]
 ds_read_b64_tr_b16 v[68:69], v8 offset:20480
 v_mfma_f32_16x16x32_bf16 v[108:111], v[228:231], v[52:55], v[108:111]
 ds_read_b64_tr_b16 v[70:71], v9 offset:20480
 s_add_u32 m0, s54, 49152
 s_add_u32 s60, s73, 393216
 buffer_load_dwordx4 v4, s[12:15], s60 offen lds
 s_waitcnt lgkmcnt(6)
 v_mfma_f32_16x16x32_bf16 v[104:107], v[168:171], v[56:59], v[104:107]
 ds_read_b64_tr_b16 v[72:73], v8 offset:24576
 v_mfma_f32_16x16x32_bf16 v[108:111], v[232:235], v[56:59], v[108:111]
 ds_read_b64_tr_b16 v[74:75], v9 offset:24576
 s_waitcnt lgkmcnt(6)
 v_mfma_f32_16x16x32_bf16 v[104:107], v[172:175], v[60:63], v[104:107]
 ds_read_b64_tr_b16 v[76:77], v8 offset:28672
 v_mfma_f32_16x16x32_bf16 v[108:111], v[236:239], v[60:63], v[108:111]
 ds_read_b64_tr_b16 v[78:79], v9 offset:28672
 s_add_u32 m0, s54, 57344
 s_add_u32 s60, s73, 589824
 buffer_load_dwordx4 v4, s[12:15], s60 offen lds
 s_waitcnt vmcnt(4)
 s_waitcnt lgkmcnt(0)
 s_barrier
 v_add_u32 v8, 0xffff0000, v8
 v_add_u32 v9, 0xffff0000, v9
 v_mfma_f32_16x16x32_bf16 v[104:107], v[176:179], v[64:67], v[104:107]
 ds_read_b64_tr_b16 v[48:49], v8 offset:0
 v_mfma_f32_16x16x32_bf16 v[108:111], v[240:243], v[64:67], v[108:111]
 ds_read_b64_tr_b16 v[50:51], v9 offset:0
 v_mfma_f32_16x16x32_bf16 v[104:107], v[180:183], v[68:71], v[104:107]
 ds_read_b64_tr_b16 v[52:53], v8 offset:4096
 v_mfma_f32_16x16x32_bf16 v[108:111], v[244:247], v[68:71], v[108:111]
 ds_read_b64_tr_b16 v[54:55], v9 offset:4096
 v_mfma_f32_16x16x32_bf16 v[104:107], v[184:187], v[72:75], v[104:107]
 ds_read_b64_tr_b16 v[56:57], v8 offset:8192
 v_mfma_f32_16x16x32_bf16 v[108:111], v[248:251], v[72:75], v[108:111]
 ds_read_b64_tr_b16 v[58:59], v9 offset:8192
 v_mfma_f32_16x16x32_bf16 v[104:107], v[188:191], v[76:79], v[104:107]
 ds_read_b64_tr_b16 v[60:61], v8 offset:12288
 v_mfma_f32_16x16x32_bf16 v[108:111], v[252:255], v[76:79], v[108:111]
 ds_read_b64_tr_b16 v[62:63], v9 offset:12288
 v_cmp_eq_u32 vcc, 0, v13
 s_cbranch_vccz L_ok_29
 s_mov_b32 s70, 50000
L_spin_30:
 s_sleep 2
 buffer_load_dwordx2 v[12:13], off, s[40:43], 0 sc1
 s_waitcnt vmcnt(0)
 s_sub_u32 s70, s70, 1
 s_cbranch_scc1 L_ok_29
 v_cmp_eq_u32 vcc, 0, v13
 s_cbranch_vccnz L_spin_30
L_ok_29:
 v_readfirstlane_b32 s53, v12
 v_mov_b32 v0, v12
 s_waitcnt lgkmcnt(6)
 v_mfma_f32_16x16x32_bf16 v[112:115], v[48:51], v[128:131], 0
 ds_read_b64_tr_b16 v[64:65], v8 offset:16384
 v_cvt_pk_bf16_f32 v84, v104, v105
 v_cvt_pk_bf16_f32 v85, v106, v107
 v_mfma_f32_16x16x32_bf16 v[116:119], v[48:51], v[192:195], 0
 ds_read_b64_tr_b16 v[66:67], v9 offset:16384
 v_cvt_pk_bf16_f32 v86, v108, v109
 v_cvt_pk_bf16_f32 v87, v110, v111
 s_waitcnt lgkmcnt(6)
 v_mfma_f32_16x16x32_bf16 v[112:115], v[52:55], v[132:135], v[112:115]
 ds_read_b64_tr_b16 v[68:69], v8 offset:20480
 s_lshl_b32 s62, s52, 11
 s_add_u32 s62, s62, 131072
 v_add_u32 v92, s62, v2
 s_lshl_b32 s62, s81, 11
 s_add_u32 s62, s62, 20971520
 s_cmp_eq_u32 s51, 0
 s_cbranch_scc1 L_kv_31
 s_mov_b32 exec_lo, 0xff00ff00
 s_mov_b32 exec_hi, 0xff00ff00
 buffer_store_dwordx4 v[80:83], v2, s[44:47], s62 offen sc1
 s_mov_b32 exec_lo, 0
 s_mov_b32 exec_hi, -1
 buffer_store_dwordx4 v[84:87], v2, s[44:47], s62 offen offset:1024 sc1
 s_mov_b64 exec, -1
 s_branch L_kv_32
L_kv_31:
 ds_write_b128 v92, v[80:83]
 ds_write_b128 v92, v[84:87] offset:1024
L_kv_32:
 v_mfma_f32_16x16x32_bf16 v[116:119], v[52:55], v[196:199], v[116:119]
 ds_read_b64_tr_b16 v[70:71], v9 offset:20480
 s_waitcnt lgkmcnt(6)
 v_mfma_f32_16x16x32_bf16 v[112:115], v[56:59], v[136:139], v[112:115]
 ds_read_b64_tr_b16 v[72:73], v8 offset:24576
 v_mfma_f32_16x16x32_bf16 v[116:119], v[56:59], v[200:203], v[116:119]
 ds_read_b64_tr_b16 v[74:75], v9 offset:24576
 s_waitcnt lgkmcnt(6)
 v_mfma_f32_16x16x32_bf16 v[112:115], v[60:63], v[140:143], v[112:115]
 ds_read_b64_tr_b16 v[76:77], v8 offset:28672
 v_mfma_f32_16x16x32_bf16 v[116:119], v[60:63], v[204:207], v[116:119]
 ds_read_b64_tr_b16 v[78:79], v9 offset:28672
 s_waitcnt vmcnt(0)
 s_waitcnt lgkmcnt(0)
 s_barrier
 v_mfma_f32_16x16x32_bf16 v[112:115], v[64:67], v[144:147], v[112:115]
 ds_read_b64_tr_b16 v[48:49], v8 offset:32768
 v_mfma_f32_16x16x32_bf16 v[116:119], v[64:67], v[208:211], v[116:119]
 ds_read_b64_tr_b16 v[50:51], v9 offset:32768
 v_mfma_f32_16x16x32_bf16 v[112:115], v[68:71], v[148:151], v[112:115]
 ds_read_b64_tr_b16 v[52:53], v8 offset:36864
 v_mfma_f32_16x16x32_bf16 v[116:119], v[68:71], v[212:215], v[116:119]
 ds_read_b64_tr_b16 v[54:55], v9 offset:36864
 v_mfma_f32_16x16x32_bf16 v[112:115], v[72:75], v[152:155], v[112:115]
 ds_read_b64_tr_b16 v[56:57], v8 offset:40960
 v_mfma_f32_16x16x32_bf16 v[116:119], v[72:75], v[216:219], v[116:119]
 ds_read_b64_tr_b16 v[58:59], v9 offset:40960
 v_mfma_f32_16x16x32_bf16 v[112:115], v[76:79], v[156:159], v[112:115]
 ds_read_b64_tr_b16 v[60:61], v8 offset:45056
 v_mfma_f32_16x16x32_bf16 v[116:119], v[76:79], v[220:223], v[116:119]
 ds_read_b64_tr_b16 v[62:63], v9 offset:45056
 s_waitcnt lgkmcnt(6)
 v_mfma_f32_16x16x32_bf16 v[112:115], v[48:51], v[160:163], v[112:115]
 ds_read_b64_tr_b16 v[64:65], v8 offset:49152
 v_mfma_f32_16x16x32_bf16 v[116:119], v[48:51], v[224:227], v[116:119]
 ds_read_b64_tr_b16 v[66:67], v9 offset:49152
 s_waitcnt lgkmcnt(6)
 v_mfma_f32_16x16x32_bf16 v[112:115], v[52:55], v[164:167], v[112:115]
 ds_read_b64_tr_b16 v[68:69], v8 offset:53248
 v_mfma_f32_16x16x32_bf16 v[116:119], v[52:55], v[228:231], v[116:119]
 ds_read_b64_tr_b16 v[70:71], v9 offset:53248
 s_waitcnt lgkmcnt(6)
 v_mfma_f32_16x16x32_bf16 v[112:115], v[56:59], v[168:171], v[112:115]
 ds_read_b64_tr_b16 v[72:73], v8 offset:57344
 v_mfma_f32_16x16x32_bf16 v[116:119], v[56:59], v[232:235], v[116:119]
 ds_read_b64_tr_b16 v[74:75], v9 offset:57344
 s_waitcnt lgkmcnt(6)
 v_mfma_f32_16x16x32_bf16 v[112:115], v[60:63], v[172:175], v[112:115]
 ds_read_b64_tr_b16 v[76:77], v8 offset:61440
 v_mfma_f32_16x16x32_bf16 v[116:119], v[60:63], v[236:239], v[116:119]
 ds_read_b64_tr_b16 v[78:79], v9 offset:61440
 s_waitcnt vmcnt(0)
 s_barrier
 s_cmp_lg_u32 s50, 0
 s_cbranch_scc1 L_fl_33
 s_lshl_b32 s61, s81, 4
 s_add_u32 s61, s61, 12582912
 s_mov_b64 exec, 1
 buffer_store_dword v0, off, s[44:47], s61 sc1
 s_mov_b64 exec, -1
L_fl_33:
 s_waitcnt lgkmcnt(6)
 v_mfma_f32_16x16x32_bf16 v[112:115], v[64:67], v[176:179], v[112:115]
 v_mfma_f32_16x16x32_bf16 v[116:119], v[64:67], v[240:243], v[116:119]
 s_waitcnt lgkmcnt(4)
 v_mfma_f32_16x16x32_bf16 v[112:115], v[68:71], v[180:183], v[112:115]
 v_mfma_f32_16x16x32_bf16 v[116:119], v[68:71], v[244:247], v[116:119]
 s_waitcnt lgkmcnt(2)
 v_mfma_f32_16x16x32_bf16 v[112:115], v[72:75], v[184:187], v[112:115]
 v_mfma_f32_16x16x32_bf16 v[116:119], v[72:75], v[248:251], v[116:119]
 s_waitcnt lgkmcnt(0)
 v_mfma_f32_16x16x32_bf16 v[112:115], v[76:79], v[188:191], v[112:115]
 v_mfma_f32_16x16x32_bf16 v[116:119], v[76:79], v[252:255], v[116:119]
 s_nop 6
 v_cvt_pk_bf16_f32 v88, v112, v113
 v_cvt_pk_bf16_f32 v89, v114, v115
 v_cvt_pk_bf16_f32 v90, v116, v117
 v_cvt_pk_bf16_f32 v91, v118, v119
 s_cmp_lg_u32 s50, 1
 s_cbranch_scc1 L_pi_34
 s_min_u32 s63, s48, 1
 s_lshl_b32 s63, s63, 6
 s_sub_u32 s63, s81, s63
 s_andn2_b32 s63, s63, 7
 s_lshl_b32 s63, s63, 4
 s_add_u32 s63, s63, 12582912
 v_writelane_b32 v13, s63, 0
 v_mov_b32 v12, 0
 s_mov_b64 exec, 0x1
 buffer_atomic_or v12, v13, s[44:47], 0 offen sc0 sc1
 s_mov_b64 exec, -1
L_pi_34:
 v_mov_b32 v16, 0
 v_mov_b32 v17, 0
 v_mov_b32 v18, 0
 v_mov_b32 v19, 0
 v_mov_b32 v20, 0
 v_mov_b32 v21, 0
 v_mov_b32 v22, 0
 v_mov_b32 v23, 0
 s_cmp_lg_u32 s50, 1
 s_cbranch_scc1 L_ok_35
 s_waitcnt vmcnt(0)
 v_cmp_ne_u32 vcc, s53, v12
 s_nop 0
 s_and_b64 vcc, vcc, 0x1
 s_cbranch_vccz L_ok_35
 s_mov_b32 s70, 50000
L_spin_36:
 s_sleep 2
 v_mov_b32 v12, 0
 s_mov_b64 exec, 0x1
 buffer_atomic_or v12, v13, s[44:47], 0 offen sc0 sc1
 s_mov_b64 exec, -1
 s_waitcnt vmcnt(0)
 s_sub_u32 s70, s70, 1
 s_cbranch_scc1 L_ok_35
 v_cmp_ne_u32 vcc, s53, v12
 s_nop 0
 s_and_b64 vcc, vcc, 0x1
 s_cbranch_vccnz L_spin_36
L_ok_35:
 s_waitcnt lgkmcnt(0)
 s_barrier
 s_min_u32 s64, s48, 1
 s_andn2_b32 s64, s64, s51
 s_sub_u32 s62, s81, 60
 s_lshl_b32 s62, s62, 11
 s_add_u32 s62, s62, 20971520
 s_cmp_lg_u32 s51, 0
 s_cbranch_scc1 L_kv_37
 s_cmp_eq_u32 s64, 0
 s_cbranch_scc1 L_kv_38
 s_mov_b32 exec_lo, 0xff00ff00
 s_mov_b32 exec_hi, 0xff00ff00
 buffer_load_dwordx4 v[16:19], v2, s[44:47], s62 offen sc1
 s_mov_b32 exec_lo, 0
 s_mov_b32 exec_hi, -1
 buffer_load_dwordx4 v[20:23], v2, s[44:47], s62 offen offset:1024 sc1
 s_mov_b64 exec, -1
 s_branch L_kv_38
L_kv_37:
 ds_read_b128 v[16:19], v92
 ds_read_b128 v[20:23], v92 offset:1024
L_kv_38:
 s_add_u32 m0, s54, 98304
 s_add_u32 s60, s59, 0
 buffer_load_dwordx4 v6, s[16:19], s60 offen lds
 s_add_u32 m0, s54, 106496
 s_add_u32 s60, s59, 65536
 buffer_load_dwordx4 v6, s[16:19], s60 offen lds
 s_add_u32 m0, s54, 114688
 s_add_u32 s60, s59, 131072
 buffer_load_dwordx4 v6, s[16:19], s60 offen lds
 s_add_u32 m0, s54, 122880
 s_add_u32 s60, s59, 458752
 buffer_load_dwordx4 v6, s[16:19], s60 offen lds
 v_mov_b32 v94, 0xf149f2ca
 s_or_b32 s62, s48, s51
 s_cselect_b32 s62, 0, 0xf149f2ca
 v_mov_b32 v95, s62
 s_mov_b32 vcc_lo, 0xf00fff00
 s_mov_b32 vcc_hi, 0xfff00ff
 v_cndmask_b32 v28, 0, v94, vcc
 s_mov_b32 vcc_lo, 0xf00fff00
 s_mov_b32 vcc_hi, 0xfff00ff
 v_cndmask_b32 v108, 0, v94, vcc
 s_mov_b32 vcc_lo, 0xe01ffe01
 s_mov_b32 vcc_hi, 0x1fff01ff
 v_cndmask_b32 v29, 0, v94, vcc
 s_mov_b32 vcc_lo, 0xe01ffe01
 s_mov_b32 vcc_hi, 0x1fff01ff
 v_cndmask_b32 v109, 0, v94, vcc
 s_mov_b32 vcc_lo, 0xc03ffc03
 s_mov_b32 vcc_hi, 0x3fff03ff
 v_cndmask_b32 v30, 0, v94, vcc
 s_mov_b32 vcc_lo, 0xc03ffc03
 s_mov_b32 vcc_hi, 0x3fff03ff
 v_cndmask_b32 v110, 0, v94, vcc
 s_mov_b32 vcc_lo, 0x807ff807
 s_mov_b32 vcc_hi, 0x7fff07ff
 v_cndmask_b32 v31, 0, v94, vcc
 s_mov_b32 vcc_lo, 0x807ff807
 s_mov_b32 vcc_hi, 0x7fff07ff
 v_cndmask_b32 v111, 0, v94, vcc
 s_mov_b32 vcc_lo, 0x0
 s_mov_b32 vcc_hi, 0xf0000
 v_cndmask_b32 v24, v94, v95, vcc
 s_mov_b32 vcc_lo, 0x0
 s_mov_b32 vcc_hi, 0xf0000
 v_cndmask_b32 v104, v94, v95, vcc
 s_mov_b32 vcc_lo, 0x0
 s_mov_b32 vcc_hi, 0x1f0001
 v_cndmask_b32 v25, v94, v95, vcc
 s_mov_b32 vcc_lo, 0x0
 s_mov_b32 vcc_hi, 0x1f0001
 v_cndmask_b32 v105, v94, v95, vcc
 s_mov_b32 vcc_lo, 0x0
 s_mov_b32 vcc_hi, 0x3f0003
 v_cndmask_b32 v26, v94, v95, vcc
 s_mov_b32 vcc_lo, 0x0
 s_mov_b32 vcc_hi, 0x3f0003
 v_cndmask_b32 v106, v94, v95, vcc
 s_mov_b32 vcc_lo, 0x0
 s_mov_b32 vcc_hi, 0x7f0007
 v_cndmask_b32 v27, v94, v95, vcc
 s_mov_b32 vcc_lo, 0x0
 s_mov_b32 vcc_hi, 0x7f0007
 v_cndmask_b32 v107, v94, v95, vcc
 v_mfma_f32_16x16x16_bf16 v[28:31], v[80:81], v[88:89], v[28:31]
 v_mfma_f32_16x16x16_bf16 v[108:111], v[82:83], v[90:91], v[108:111]
 s_waitcnt vmcnt(4)
 s_waitcnt lgkmcnt(0)
 v_mfma_f32_16x16x16_bf16 v[24:27], v[16:17], v[88:89], v[24:27]
 v_mfma_f32_16x16x16_bf16 v[104:107], v[18:19], v[90:91], v[104:107]
 s_nop 2
 v_max3_f32 v97, v28, v29, v30
 v_max3_f32 v99, v108, v109, v110
 s_nop 1
 v_max3_f32 v96, v24, v25, v26
 v_max3_f32 v98, v104, v105, v106
 v_max3_f32 v96, v96, v27, v31
 v_max3_f32 v98, v98, v107, v111
 v_max_f32 v96, v96, v97
 v_max_f32 v98, v98, v99
 v_mov_b32 v97, v96
 v_mov_b32 v99, v98
 s_nop 0
 v_permlane16_swap_b32 v96, v97
 v_permlane16_swap_b32 v98, v99
 v_max_f32 v96, v96, v97
 v_max_f32 v98, v98, v99
 v_mov_b32 v97, v96
 v_mov_b32 v99, v98
 s_nop 0
 v_permlane32_swap_b32 v96, v97
 v_permlane32_swap_b32 v98, v99
 v_max_f32 v96, v96, v97
 v_max_f32 v98, v98, v99
 v_mul_f32 v96, 0xbeb8aa3b, v96
 v_mul_f32 v98, 0xbeb8aa3b, v98
 v_fmamk_f32 v24, v24, 0x3eb8aa3b, v96
 v_fmamk_f32 v104, v104, 0x3eb8aa3b, v98
 v_fmamk_f32 v25, v25, 0x3eb8aa3b, v96
 v_fmamk_f32 v105, v105, 0x3eb8aa3b, v98
 v_fmamk_f32 v26, v26, 0x3eb8aa3b, v96
 v_fmamk_f32 v106, v106, 0x3eb8aa3b, v98
 v_fmamk_f32 v27, v27, 0x3eb8aa3b, v96
 v_fmamk_f32 v107, v107, 0x3eb8aa3b, v98
 v_fmamk_f32 v28, v28, 0x3eb8aa3b, v96
 v_fmamk_f32 v108, v108, 0x3eb8aa3b, v98
 v_fmamk_f32 v29, v29, 0x3eb8aa3b, v96
 v_fmamk_f32 v109, v109, 0x3eb8aa3b, v98
 v_fmamk_f32 v30, v30, 0x3eb8aa3b, v96
 v_fmamk_f32 v110, v110, 0x3eb8aa3b, v98
 v_fmamk_f32 v31, v31, 0x3eb8aa3b, v96
 v_fmamk_f32 v111, v111, 0x3eb8aa3b, v98
 v_exp_f32 v24, v24
 v_exp_f32 v104, v104
 v_exp_f32 v25, v25
 v_exp_f32 v105, v105
 v_exp_f32 v26, v26
 v_exp_f32 v106, v106
 v_exp_f32 v27, v27
 v_exp_f32 v107, v107
 v_exp_f32 v28, v28
 v_exp_f32 v108, v108
 v_exp_f32 v29, v29
 v_exp_f32 v109, v109
 v_exp_f32 v30, v30
 v_exp_f32 v110, v110
 v_exp_f32 v31, v31
 v_exp_f32 v111, v111
 v_add_f32 v96, v24, v25
 v_add_f32 v98, v104, v105
 v_add_f32 v97, v26, v27
 v_add_f32 v99, v106, v107
 v_add_f32 v96, v96, v28
 v_add_f32 v98, v98, v108
 v_add_f32 v97, v97, v29
 v_add_f32 v99, v99, v109
 v_add_f32 v96, v96, v30
 v_add_f32 v98, v98, v110
 v_add_f32 v97, v97, v31
 v_add_f32 v99, v99, v111
 v_cvt_pk_bf16_f32 v24, v24, v25
 v_cvt_pk_bf16_f32 v104, v104, v105
 v_cvt_pk_bf16_f32 v25, v26, v27
 v_cvt_pk_bf16_f32 v105, v106, v107
 v_cvt_pk_bf16_f32 v26, v28, v29
 v_cvt_pk_bf16_f32 v106, v108, v109
 v_cvt_pk_bf16_f32 v27, v30, v31
 v_cvt_pk_bf16_f32 v107, v110, v111
 v_add_f32 v96, v96, v97
 v_add_f32 v98, v98, v99
 v_mfma_f32_16x16x16_bf16 v[28:31], v[20:21], v[24:25], 0
 v_mfma_f32_16x16x16_bf16 v[108:111], v[22:23], v[104:105], 0
 v_mfma_f32_16x16x16_bf16 v[28:31], v[84:85], v[26:27], v[28:31]
 v_mfma_f32_16x16x16_bf16 v[108:111], v[86:87], v[106:107], v[108:111]
 v_mov_b32 v97, v96
 v_mov_b32 v99, v98
 s_nop 0
 v_permlane16_swap_b32 v96, v97
 v_permlane16_swap_b32 v98, v99
 v_add_f32 v96, v96, v97
 v_add_f32 v98, v98, v99
 v_mov_b32 v97, v96
 v_mov_b32 v99, v98
 s_nop 0
 v_permlane32_swap_b32 v96, v97
 v_permlane32_swap_b32 v98, v99
 v_add_f32 v96, v96, v97
 v_add_f32 v98, v98, v99
 v_rcp_f32 v96, v96
 v_rcp_f32 v98, v98
 v_mul_f32 v28, v28, v96
 v_mul_f32 v108, v108, v98
 v_mul_f32 v29, v29, v96
 v_mul_f32 v109, v109, v98
 v_mul_f32 v30, v30, v96
 v_mul_f32 v110, v110, v98
 v_mul_f32 v31, v31, v96
 v_mul_f32 v111, v111, v98
 v_cvt_pk_bf16_f32 v88, v28, v29
 v_cvt_pk_bf16_f32 v90, v108, v109
 v_cvt_pk_bf16_f32 v89, v30, v31
 v_cvt_pk_bf16_f32 v91, v110, v111
 v_and_b32 v92, 0xf0, v2
 v_lshrrev_b32 v93, 5, v1
 v_lshl_add_u32 v92, v93, 8, v92
 v_bfe_u32 v93, v1, 4, 1
 v_lshl_add_u32 v92, v93, 14, v92
 v_permlane16_swap_b32 v88, v90
 v_permlane16_swap_b32 v89, v91
 s_lshl_b32 s62, s48, 1
 s_add_u32 s62, s62, s51
 s_lshl_b32 s62, s62, 4
 s_add_u32 s62, s62, s65
 s_lshl_b32 s62, s62, 2
 s_add_u32 s62, s62, s52
 s_lshl_b32 s62, s62, 9
 s_add_u32 s62, s62, 4194304
 buffer_store_dwordx4 v[88:91], v92, s[44:47], s62 offen sc1
 s_nop 1
 s_waitcnt vmcnt(0)
 s_waitcnt lgkmcnt(0)
 s_barrier
 s_cmp_lg_u32 s50, 0
 s_cbranch_scc1 L_fl_39
 s_lshl_b32 s61, s81, 4
 s_add_u32 s61, s61, 12845056
 s_mov_b64 exec, 1
 buffer_store_dword v0, off, s[44:47], s61 sc1
 s_mov_b64 exec, -1
L_fl_39:
 s_add_u32 m0, s54, 65536
 s_add_u32 s60, s59, 262144
 buffer_load_dwordx4 v6, s[16:19], s60 offen lds
 s_add_u32 m0, s54, 73728
 s_add_u32 s60, s59, 327680
 buffer_load_dwordx4 v6, s[16:19], s60 offen lds
 s_add_u32 m0, s54, 81920
 s_add_u32 s60, s59, 393216
 buffer_load_dwordx4 v6, s[16:19], s60 offen lds
 s_add_u32 m0, s54, 90112
 s_add_u32 s60, s59, 196608
 buffer_load_dwordx4 v6, s[16:19], s60 offen lds
 s_lshl_b32 s71, s3, 9
 s_add_u32 s71, s71, s59
 s_add_u32 m0, s54, 0
 s_xor_b32 s60, s71, 0
 buffer_load_dwordx4 v6, s[32:35], s60 offen lds
 s_add_u32 m0, s54, 8192
 s_xor_b32 s60, s71, 65536
 buffer_load_dwordx4 v6, s[32:35], s60 offen lds
 s_add_u32 m0, s54, 16384
 s_xor_b32 s60, s71, 131072
 buffer_load_dwordx4 v6, s[32:35], s60 offen lds
 s_add_u32 m0, s54, 24576
 s_xor_b32 s60, s71, 196608
 buffer_load_dwordx4 v6, s[32:35], s60 offen lds
 s_lshl_b32 s71, s3, 9
 s_add_u32 s71, s71, s59
 s_add_u32 m0, s54, 32768
 s_xor_b32 s60, s71, 262144
 buffer_load_dwordx4 v6, s[32:35], s60 offen lds
 s_add_u32 m0, s54, 40960
 s_xor_b32 s60, s71, 327680
 buffer_load_dwordx4 v6, s[32:35], s60 offen lds
 s_add_u32 m0, s54, 49152
 s_xor_b32 s60, s71, 393216
 buffer_load_dwordx4 v6, s[32:35], s60 offen lds
 s_add_u32 m0, s54, 57344
 s_xor_b32 s60, s71, 458752
 buffer_load_dwordx4 v6, s[32:35], s60 offen lds
 s_cmp_lg_u32 s50, 1
 s_cbranch_scc1 L_pi_40
 s_lshl_b32 s62, s48, 10
 s_add_u32 s62, s62, 12845056
 v_lshl_add_u32 v13, v1, 7, s62
 v_mov_b32 v12, 0
 s_mov_b64 exec, 0xff
 buffer_atomic_or v12, v13, s[44:47], 0 offen sc0 sc1
 s_mov_b64 exec, -1
L_pi_40:
 s_cmp_lg_u32 s50, 1
 s_cbranch_scc1 L_ok_41
 s_waitcnt vmcnt(0)
 v_cmp_ne_u32 vcc, s53, v12
 s_nop 0
 s_and_b64 vcc, vcc, 0xff
 s_cbranch_vccz L_ok_41
 s_mov_b32 s70, 50000
L_spin_42:
 s_sleep 2
 v_mov_b32 v12, 0
 s_mov_b64 exec, 0xff
 buffer_atomic_or v12, v13, s[44:47], 0 offen sc0 sc1
 s_mov_b64 exec, -1
 s_waitcnt vmcnt(0)
 s_sub_u32 s70, s70, 1
 s_cbranch_scc1 L_ok_41
 v_cmp_ne_u32 vcc, s53, v12
 s_nop 0
 s_and_b64 vcc, vcc, 0xff
 s_cbranch_vccnz L_spin_42
L_ok_41:
 s_waitcnt lgkmcnt(0)
 s_barrier
 s_lshl_b32 s64, s48, 2
 s_add_u32 s64, s64, s52
 s_lshl_b32 s64, s64, 4
 s_add_u32 s64, s64, s51
 s_lshl_b32 s64, s64, 10
 s_add_u32 s64, s64, 4194304
 s_add_u32 s60, s64, 0
 buffer_load_dwordx4 v[128:131], v2, s[44:47], s60 offen sc1
 s_add_u32 s60, s64, 2048
 buffer_load_dwordx4 v[132:135], v2, s[44:47], s60 offen sc1
 s_add_u32 s60, s64, 4096
 buffer_load_dwordx4 v[136:139], v2, s[44:47], s60 offen sc1
 s_add_u32 s60, s64, 14336
 buffer_load_dwordx4 v[140:143], v2, s[44:47], s60 offen sc1
 s_add_u32 s60, s64, 8192
 buffer_load_dwordx4 v[144:147], v2, s[44:47], s60 offen sc1
 s_add_u32 s60, s64, 10240
 buffer_load_dwordx4 v[148:151], v2, s[44:47], s60 offen sc1
 s_add_u32 s60, s64, 12288
 buffer_load_dwordx4 v[152:155], v2, s[44:47], s60 offen sc1
 s_add_u32 s60, s64, 6144
 buffer_load_dwordx4 v[156:159], v2, s[44:47], s60 offen sc1
 v_lshrrev_b32 v112, 4, v1
 v_and_b32 v114, 3, v1
 v_bfe_u32 v113, v1, 2, 2
 v_lshl_add_u32 v3, v112, 3, v113
 v_lshlrev_b32 v3, 7, v3
 v_lshl_add_u32 v3, v114, 3, v3
 v_lshrrev_b32 v4, 2, v1
 v_lshlrev_b32 v4, 7, v4
 v_lshl_add_u32 v4, v114, 3, v4
 v_lshrrev_b32 v113, 1, v113
 v_xor_b32 v114, s51, v112
 v_and_b32 v115, 1, v114
 v_lshl_add_u32 v115, v115, 1, v113
 v_lshl_add_u32 v3, v115, 5, v3
 v_lshrrev_b32 v112, 1, v112
 v_xor_b32 v114, v114, v112
 v_and_b32 v114, 1, v114
 v_lshl_add_u32 v114, v114, 1, v113
 v_lshl_add_u32 v4, v114, 5, v4
 s_lshl_b32 s63, s51, 12
 v_add_u32 v3, s63, v3
 s_lshl_b32 s63, s51, 11
 v_add_u32 v4, s63, v4
 s_waitcnt lgkmcnt(0)
 s_barrier
 v_add_u32 v8, 65536, v3
 v_xor_b32 v9, 32, v8
 v_xor_b32 v10, 64, v8
 v_xor_b32 v11, 96, v8
 ds_read_b64_tr_b16 v[48:49], v8 offset:32768
 ds_read_b64_tr_b16 v[50:51], v10 offset:33280
 ds_read_b64_tr_b16 v[52:53], v9 offset:32768
 ds_read_b64_tr_b16 v[54:55], v11 offset:33280
 ds_read_b64_tr_b16 v[56:57], v10 offset:32768
 ds_read_b64_tr_b16 v[58:59], v8 offset:33280
 ds_read_b64_tr_b16 v[60:61], v11 offset:32768
 ds_read_b64_tr_b16 v[62:63], v9 offset:33280
 s_waitcnt vmcnt(7)
 s_waitcnt lgkmcnt(6)
 v_mfma_f32_16x16x32_bf16 v[96:99], v[48:51], v[128:131], 0
 ds_read_b64_tr_b16 v[64:65], v8 offset:40960
 ds_read_b64_tr_b16 v[66:67], v10 offset:41472
 v_and_b32 v16, 15, v1
 s_waitcnt lgkmcnt(6)
 v_mfma_f32_16x16x32_bf16 v[100:103], v[52:55], v[128:131], 0
 ds_read_b64_tr_b16 v[68:69], v9 offset:40960
 ds_read_b64_tr_b16 v[70:71], v11 offset:41472
 v_lshrrev_b32 v17, 4, v1
 s_waitcnt lgkmcnt(6)
 v_mfma_f32_16x16x32_bf16 v[104:107], v[56:59], v[128:131], 0
 ds_read_b64_tr_b16 v[72:73], v10 offset:40960
 ds_read_b64_tr_b16 v[74:75], v8 offset:41472
 v_and_b32 v18, 7, v1
 s_waitcnt lgkmcnt(6)
 v_mfma_f32_16x16x32_bf16 v[108:111], v[60:63], v[128:131], 0
 ds_read_b64_tr_b16 v[76:77], v11 offset:40960
 ds_read_b64_tr_b16 v[78:79], v9 offset:41472
 v_xor_b32 v17, v17, v18
 s_waitcnt vmcnt(6)
 s_waitcnt lgkmcnt(6)
 v_mfma_f32_16x16x32_bf16 v[96:99], v[64:67], v[132:135], v[96:99]
 ds_read_b64_tr_b16 v[48:49], v8 offset:49152
 ds_read_b64_tr_b16 v[50:51], v10 offset:49664
 s_lshl_b32 s62, s51, 3
 v_xor_b32 v17, s62, v17
 s_waitcnt lgkmcnt(6)
 v_mfma_f32_16x16x32_bf16 v[100:103], v[68:71], v[132:135], v[100:103]
 ds_read_b64_tr_b16 v[52:53], v9 offset:49152
 ds_read_b64_tr_b16 v[54:55], v11 offset:49664
 v_lshlrev_b32 v17, 4, v17
 s_waitcnt lgkmcnt(6)
 v_mfma_f32_16x16x32_bf16 v[104:107], v[72:75], v[132:135], v[104:107]
 ds_read_b64_tr_b16 v[56:57], v10 offset:49152
 ds_read_b64_tr_b16 v[58:59], v8 offset:49664
 v_lshl_add_u32 v14, v16, 8, v17
 s_waitcnt lgkmcnt(6)
 v_mfma_f32_16x16x32_bf16 v[108:111], v[76:79], v[132:135], v[108:111]
 ds_read_b64_tr_b16 v[60:61], v11 offset:49152
 ds_read_b64_tr_b16 v[62:63], v9 offset:49664
 s_lshl_b32 s62, s50, 12
 s_add_u32 s62, s62, 131072
 v_add_u32 v14, s62, v14
 s_waitcnt vmcnt(5)
 s_waitcnt lgkmcnt(6)
 v_mfma_f32_16x16x32_bf16 v[96:99], v[48:51], v[136:139], v[96:99]
 ds_read_b64_tr_b16 v[64:65], v8 offset:57344
 ds_read_b64_tr_b16 v[66:67], v10 offset:57856
 v_xor_b32 v3, 64, v14
 s_waitcnt lgkmcnt(6)
 v_mfma_f32_16x16x32_bf16 v[100:103], v[52:55], v[136:139], v[100:103]
 ds_read_b64_tr_b16 v[68:69], v9 offset:57344
 ds_read_b64_tr_b16 v[70:71], v11 offset:57856
 v_xor_b32 v5, 192, v14
 s_waitcnt lgkmcnt(6)
 v_mfma_f32_16x16x32_bf16 v[104:107], v[56:59], v[136:139], v[104:107]
 ds_read_b64_tr_b16 v[72:73], v10 offset:57344
 ds_read_b64_tr_b16 v[74:75], v8 offset:57856
 v_lshrrev_b32 v16, 3, v1
 s_waitcnt lgkmcnt(6)
 v_mfma_f32_16x16x32_bf16 v[108:111], v[60:63], v[136:139], v[108:111]
 ds_read_b64_tr_b16 v[76:77], v11 offset:57344
 ds_read_b64_tr_b16 v[78:79], v9 offset:57856
 v_lshlrev_b32 v18, 1, v18
 s_waitcnt lgkmcnt(0)
 s_barrier
 s_waitcnt vmcnt(4)
 v_mfma_f32_16x16x32_bf16 v[96:99], v[64:67], v[140:143], v[96:99]
 ds_read_b64_tr_b16 v[48:49], v8 offset:0
 ds_read_b64_tr_b16 v[50:51], v10 offset:512
 v_xor_b32 v18, v18, v16
 v_mfma_f32_16x16x32_bf16 v[100:103], v[68:71], v[140:143], v[100:103]
 ds_read_b64_tr_b16 v[52:53], v9 offset:0
 ds_read_b64_tr_b16 v[54:55], v11 offset:512
 s_lshl_b32 s71, s3, 9
 s_add_u32 s71, s71, s59
 s_add_u32 m0, s54, 98304
 s_xor_b32 s60, s71, 524288
 buffer_load_dwordx4 v6, s[32:35], s60 offen lds
 v_lshlrev_b32 v18, 4, v18
 v_mfma_f32_16x16x32_bf16 v[104:107], v[72:75], v[140:143], v[104:107]
 ds_read_b64_tr_b16 v[56:57], v10 offset:0
 ds_read_b64_tr_b16 v[58:59], v8 offset:512
 v_lshl_add_u32 v15, v16, 8, v18
 v_mfma_f32_16x16x32_bf16 v[108:111], v[76:79], v[140:143], v[108:111]
 ds_read_b64_tr_b16 v[60:61], v11 offset:0
 ds_read_b64_tr_b16 v[62:63], v9 offset:512
 s_add_u32 m0, s54, 106496
 s_xor_b32 s60, s71, 589824
 buffer_load_dwordx4 v6, s[32:35], s60 offen lds
 s_lshl_b32 s62, s50, 11
 s_add_u32 s62, s62, 131072
 v_add_u32 v15, s62, v15
 s_waitcnt vmcnt(5)
 s_waitcnt lgkmcnt(6)
 v_mfma_f32_16x16x32_bf16 v[96:99], v[48:51], v[144:147], v[96:99]
 ds_read_b64_tr_b16 v[64:65], v8 offset:8192
 ds_read_b64_tr_b16 v[66:67], v10 offset:8704
 v_xor_b32 v7, 16, v15
 s_waitcnt lgkmcnt(6)
 v_mfma_f32_16x16x32_bf16 v[100:103], v[52:55], v[144:147], v[100:103]
 ds_read_b64_tr_b16 v[68:69], v9 offset:8192
 ds_read_b64_tr_b16 v[70:71], v11 offset:8704
 s_add_u32 m0, s54, 114688
 s_xor_b32 s60, s71, 655360
 buffer_load_dwordx4 v6, s[32:35], s60 offen lds
 s_lshl_b32 s68, s48, 2
 s_add_u32 s68, s68, s52
 s_mul_i32 s68, s68, 28
 s_waitcnt lgkmcnt(6)
 v_mfma_f32_16x16x32_bf16 v[104:107], v[56:59], v[144:147], v[104:107]
 ds_read_b64_tr_b16 v[72:73], v10 offset:8192
 ds_read_b64_tr_b16 v[74:75], v8 offset:8704
 s_add_u32 s68, s68, s51
 s_lshl_b32 s68, s68, 10
 s_add_u32 s68, s68, 8388608
 s_waitcnt lgkmcnt(6)
 v_mfma_f32_16x16x32_bf16 v[108:111], v[60:63], v[144:147], v[108:111]
 ds_read_b64_tr_b16 v[76:77], v11 offset:8192
 ds_read_b64_tr_b16 v[78:79], v9 offset:8704
 s_add_u32 m0, s54, 122880
 s_xor_b32 s60, s71, 720896
 buffer_load_dwordx4 v6, s[32:35], s60 offen lds
 s_waitcnt vmcnt(6)
 s_waitcnt lgkmcnt(6)
 v_mfma_f32_16x16x32_bf16 v[96:99], v[64:67], v[148:151], v[96:99]
 ds_read_b64_tr_b16 v[48:49], v8 offset:16384
 ds_read_b64_tr_b16 v[50:51], v10 offset:16896
 s_waitcnt lgkmcnt(6)
 v_mfma_f32_16x16x32_bf16 v[100:103], v[68:71], v[148:151], v[100:103]
 ds_read_b64_tr_b16 v[52:53], v9 offset:16384
 ds_read_b64_tr_b16 v[54:55], v11 offset:16896
 s_waitcnt lgkmcnt(6)
 v_mfma_f32_16x16x32_bf16 v[104:107], v[72:75], v[148:151], v[104:107]
 ds_read_b64_tr_b16 v[56:57], v10 offset:16384
 ds_read_b64_tr_b16 v[58:59], v8 offset:16896
 s_waitcnt lgkmcnt(6)
 v_mfma_f32_16x16x32_bf16 v[108:111], v[76:79], v[148:151], v[108:111]
 ds_read_b64_tr_b16 v[60:61], v11 offset:16384
 ds_read_b64_tr_b16 v[62:63], v9 offset:16896
 v_lshrrev_b32 v160, 3, v1
 v_and_b32 v161, 0x70, v2
 v_lshl_add_u32 v160, v160, 11, v161
 s_lshr_b32 s79, s69, 12
 s_lshl_b32 s79, s79, 10
 s_lshl_b32 s62, s65, 7
 s_add_u32 s79, s79, s62
 buffer_load_dwordx4 v[162:165], v160, s[8:11], s79 offen
 s_waitcnt vmcnt(6)
 s_waitcnt lgkmcnt(6)
 v_mfma_f32_16x16x32_bf16 v[96:99], v[48:51], v[152:155], v[96:99]
 ds_read_b64_tr_b16 v[64:65], v8 offset:24576
 ds_read_b64_tr_b16 v[66:67], v10 offset:25088
 s_waitcnt lgkmcnt(6)
 v_mfma_f32_16x16x32_bf16 v[100:103], v[52:55], v[152:155], v[100:103]
 ds_read_b64_tr_b16 v[68:69], v9 offset:24576
 ds_read_b64_tr_b16 v[70:71], v11 offset:25088
 s_waitcnt lgkmcnt(6)
 v_mfma_f32_16x16x32_bf16 v[104:107], v[56:59], v[152:155], v[104:107]
 ds_read_b64_tr_b16 v[72:73], v10 offset:24576
 ds_read_b64_tr_b16 v[74:75], v8 offset:25088
 s_waitcnt lgkmcnt(6)
 v_mfma_f32_16x16x32_bf16 v[108:111], v[60:63], v[152:155], v[108:111]
 ds_read_b64_tr_b16 v[76:77], v11 offset:24576
 ds_read_b64_tr_b16 v[78:79], v9 offset:25088
 s_waitcnt vmcnt(5)
 s_waitcnt lgkmcnt(6)
 v_mfma_f32_16x16x32_bf16 v[96:99], v[64:67], v[156:159], v[96:99]
 s_waitcnt lgkmcnt(4)
 v_mfma_f32_16x16x32_bf16 v[100:103], v[68:71], v[156:159], v[100:103]
 s_waitcnt lgkmcnt(2)
 v_mfma_f32_16x16x32_bf16 v[104:107], v[72:75], v[156:159], v[104:107]
 s_waitcnt lgkmcnt(0)
 v_mfma_f32_16x16x32_bf16 v[108:111], v[76:79], v[156:159], v[108:111]
 s_cmp_lg_u32 s50, 1
 s_cbranch_scc1 L_pi_43
 s_lshl_b32 s62, s48, 10
 s_add_u32 s62, s62, 13107200
 v_lshl_add_u32 v13, v1, 7, s62
 v_mov_b32 v12, 0
 s_mov_b64 exec, 0x7f
 buffer_atomic_or v12, v13, s[44:47], 0 offen sc0 sc1
 s_mov_b64 exec, -1
L_pi_43:
 v_add_u32 v8, 0, v4
 v_xor_b32 v9, 32, v8
 v_xor_b32 v10, 64, v8
 v_xor_b32 v11, 96, v8
 v_xor_b32 v4, 128, v14
 ds_write_b128 v14, v[96:99]
 ds_write_b128 v3, v[100:103]
 ds_write_b128 v4, v[104:107]
 ds_write_b128 v5, v[108:111]
 ds_read_b64_tr_b16 v[16:17], v8 offset:0
 ds_read_b64_tr_b16 v[18:19], v8 offset:8192
 ds_read_b64_tr_b16 v[20:21], v9 offset:0
 ds_read_b64_tr_b16 v[22:23], v9 offset:8192
 ds_read_b64_tr_b16 v[24:25], v10 offset:0
 ds_read_b64_tr_b16 v[26:27], v10 offset:8192
 ds_read_b64_tr_b16 v[28:29], v11 offset:0
 ds_read_b64_tr_b16 v[30:31], v11 offset:8192
 ds_read_b64_tr_b16 v[32:33], v8 offset:4096
 ds_read_b64_tr_b16 v[34:35], v8 offset:12288
 ds_read_b64_tr_b16 v[36:37], v9 offset:4096
 ds_read_b64_tr_b16 v[38:39], v9 offset:12288
 ds_read_b64_tr_b16 v[40:41], v10 offset:4096
 ds_read_b64_tr_b16 v[42:43], v10 offset:12288
 ds_read_b64_tr_b16 v[44:45], v11 offset:4096
 ds_read_b64_tr_b16 v[46:47], v11 offset:12288
 ds_read_b64_tr_b16 v[48:49], v8 offset:16384
 ds_read_b64_tr_b16 v[50:51], v8 offset:24576
 ds_read_b64_tr_b16 v[52:53], v9 offset:16384
 ds_read_b64_tr_b16 v[54:55], v9 offset:24576
 ds_read_b64_tr_b16 v[56:57], v10 offset:16384
 ds_read_b64_tr_b16 v[58:59], v10 offset:24576
 ds_read_b64_tr_b16 v[60:61], v11 offset:16384
 ds_read_b64_tr_b16 v[62:63], v11 offset:24576
 ds_read_b64_tr_b16 v[64:65], v8 offset:20480
 ds_read_b64_tr_b16 v[66:67], v8 offset:28672
 ds_read_b64_tr_b16 v[68:69], v9 offset:20480
 ds_read_b64_tr_b16 v[70:71], v9 offset:28672
 ds_read_b64_tr_b16 v[72:73], v10 offset:20480
 ds_read_b64_tr_b16 v[74:75], v10 offset:28672
 ds_read_b64_tr_b16 v[76:77], v11 offset:20480
 ds_read_b64_tr_b16 v[78:79], v11 offset:28672
 s_cmp_lg_u32 s50, 1
 s_cbranch_scc1 L_ok_44
 s_waitcnt vmcnt(0)
 v_cmp_ne_u32 vcc, s53, v12
 s_nop 0
 s_and_b64 vcc, vcc, 0x7f
 s_cbranch_vccz L_ok_44
 s_mov_b32 s70, 50000
L_spin_45:
 s_sleep 2
 v_mov_b32 v12, 0
 s_mov_b64 exec, 0x7f
 buffer_atomic_or v12, v13, s[44:47], 0 offen sc0 sc1
 s_mov_b64 exec, -1
 s_waitcnt vmcnt(0)
 s_sub_u32 s70, s70, 1
 s_cbranch_scc1 L_ok_44
 v_cmp_ne_u32 vcc, s53, v12
 s_nop 0
 s_and_b64 vcc, vcc, 0x7f
 s_cbranch_vccnz L_spin_45
L_ok_44:
 s_waitcnt lgkmcnt(0)
 s_barrier
 s_lshl_b32 s71, s3, 9
 s_add_u32 s71, s71, s59
 s_add_u32 m0, s54, 65536
 s_xor_b32 s60, s71, 786432
 buffer_load_dwordx4 v6, s[32:35], s60 offen lds
 s_add_u32 m0, s54, 73728
 s_xor_b32 s60, s71, 851968
 buffer_load_dwordx4 v6, s[32:35], s60 offen lds
 s_add_u32 s60, s68, 0
 buffer_load_dwordx4 v[168:171], v2, s[44:47], s60 offen offset:0 sc1
 buffer_load_dwordx4 v[172:175], v2, s[44:47], s60 offen offset:2048 sc1
 s_add_u32 s60, s68, 4096
 buffer_load_dwordx4 v[176:179], v2, s[44:47], s60 offen offset:0 sc1
 buffer_load_dwordx4 v[180:183], v2, s[44:47], s60 offen offset:2048 sc1
 ds_read_b128 v[96:99], v15 offset:0
 ds_read_b128 v[100:103], v7 offset:0
 ds_read_b128 v[104:107], v15 offset:16384
 ds_read_b128 v[108:111], v7 offset:16384
 ds_read_b64_tr_b16 v[80:81], v8 offset:32768
 ds_read_b64_tr_b16 v[82:83], v8 offset:40960
 ds_read_b64_tr_b16 v[84:85], v9 offset:32768
 ds_read_b64_tr_b16 v[86:87], v9 offset:40960
 ds_read_b64_tr_b16 v[88:89], v10 offset:32768
 ds_read_b64_tr_b16 v[90:91], v10 offset:40960
 ds_read_b64_tr_b16 v[92:93], v11 offset:32768
 ds_read_b64_tr_b16 v[94:95], v11 offset:40960
 s_add_u32 s60, s68, 8192
 buffer_load_dwordx4 v[184:187], v2, s[44:47], s60 offen offset:0 sc1
 ds_read_b64_tr_b16 v[128:129], v8 offset:36864
 ds_read_b64_tr_b16 v[130:131], v8 offset:45056
 ds_read_b64_tr_b16 v[132:133], v9 offset:36864
 ds_read_b64_tr_b16 v[134:135], v9 offset:45056
 ds_read_b64_tr_b16 v[136:137], v10 offset:36864
 ds_read_b64_tr_b16 v[138:139], v10 offset:45056
 ds_read_b64_tr_b16 v[140:141], v11 offset:36864
 ds_read_b64_tr_b16 v[142:143], v11 offset:45056
 buffer_load_dwordx4 v[188:191], v2, s[44:47], s60 offen offset:2048 sc1
 ds_read_b64_tr_b16 v[144:145], v8 offset:49152
 ds_read_b64_tr_b16 v[146:147], v8 offset:57344
 ds_read_b64_tr_b16 v[148:149], v9 offset:49152
 ds_read_b64_tr_b16 v[150:151], v9 offset:57344
 ds_read_b64_tr_b16 v[152:153], v10 offset:49152
 ds_read_b64_tr_b16 v[154:155], v10 offset:57344
 ds_read_b64_tr_b16 v[156:157], v11 offset:49152
 ds_read_b64_tr_b16 v[158:159], v11 offset:57344
 ds_read_b64_tr_b16 v[224:225], v8 offset:53248
 ds_read_b64_tr_b16 v[226:227], v8 offset:61440
 ds_read_b64_tr_b16 v[228:229], v9 offset:53248
 ds_read_b64_tr_b16 v[230:231], v9 offset:61440
 ds_read_b64_tr_b16 v[232:233], v10 offset:53248
 ds_read_b64_tr_b16 v[234:235], v10 offset:61440
 ds_read_b64_tr_b16 v[236:237], v11 offset:53248
 ds_read_b64_tr_b16 v[238:239], v11 offset:61440
 s_waitcnt lgkmcnt(15)
 v_add_f32 v96, v96, v104
 v_add_f32 v97, v97, v105
 v_add_f32 v98, v98, v106
 v_add_f32 v99, v99, v107
 v_add_f32 v100, v100, v108
 v_add_f32 v101, v101, v109
 v_add_f32 v102, v102, v110
 v_add_f32 v103, v103, v111
 s_waitcnt vmcnt(8)
 v_lshlrev_b32 v104, 16, v162
 v_and_b32 v105, s67, v162
 v_lshlrev_b32 v106, 16, v163
 v_and_b32 v107, s67, v163
 v_lshlrev_b32 v108, 16, v164
 v_and_b32 v109, s67, v164
 v_lshlrev_b32 v110, 16, v165
 v_and_b32 v111, s67, v165
 s_waitcnt vmcnt(5)
 v_mfma_f32_16x16x32_bf16 v[112:115], v[16:19], v[168:171], 0
 s_add_u32 s60, s68, 12288
 buffer_load_dwordx4 v[192:195], v2, s[44:47], s60 offen offset:0 sc1
 v_mfma_f32_16x16x32_bf16 v[116:119], v[20:23], v[168:171], 0
 v_mfma_f32_16x16x32_bf16 v[120:123], v[24:27], v[168:171], 0
 v_mfma_f32_16x16x32_bf16 v[124:127], v[28:31], v[168:171], 0
 s_waitcnt vmcnt(5)
 v_mfma_f32_16x16x32_bf16 v[112:115], v[32:35], v[172:175], v[112:115]
 buffer_load_dwordx4 v[196:199], v2, s[44:47], s60 offen offset:2048 sc1
 v_mfma_f32_16x16x32_bf16 v[116:119], v[36:39], v[172:175], v[116:119]
 v_mfma_f32_16x16x32_bf16 v[120:123], v[40:43], v[172:175], v[120:123]
 v_mfma_f32_16x16x32_bf16 v[124:127], v[44:47], v[172:175], v[124:127]
 s_waitcnt vmcnt(5)
 v_mfma_f32_16x16x32_bf16 v[112:115], v[48:51], v[176:179], v[112:115]
 s_add_u32 s60, s68, 16384
 buffer_load_dwordx4 v[200:203], v2, s[44:47], s60 offen offset:0 sc1
 v_mfma_f32_16x16x32_bf16 v[116:119], v[52:55], v[176:179], v[116:119]
 v_mfma_f32_16x16x32_bf16 v[120:123], v[56:59], v[176:179], v[120:123]
 v_mfma_f32_16x16x32_bf16 v[124:127], v[60:63], v[176:179], v[124:127]
 s_waitcnt vmcnt(5)
 v_mfma_f32_16x16x32_bf16 v[112:115], v[64:67], v[180:183], v[112:115]
 buffer_load_dwordx4 v[204:207], v2, s[44:47], s60 offen offset:2048 sc1
 v_mfma_f32_16x16x32_bf16 v[116:119], v[68:71], v[180:183], v[116:119]
 v_mfma_f32_16x16x32_bf16 v[120:123], v[72:75], v[180:183], v[120:123]
 v_mfma_f32_16x16x32_bf16 v[124:127], v[76:79], v[180:183], v[124:127]
 s_waitcnt vmcnt(5)
 v_mfma_f32_16x16x32_bf16 v[112:115], v[80:83], v[184:187], v[112:115]
 s_add_u32 s60, s68, 20480
 buffer_load_dwordx4 v[208:211], v2, s[44:47], s60 offen offset:0 sc1
 v_mfma_f32_16x16x32_bf16 v[116:119], v[84:87], v[184:187], v[116:119]
 v_mfma_f32_16x16x32_bf16 v[120:123], v[88:91], v[184:187], v[120:123]
 v_mfma_f32_16x16x32_bf16 v[124:127], v[92:95], v[184:187], v[124:127]
 s_barrier
 v_add_u32 v8, 0x10000, v8
 v_add_u32 v9, 0x10000, v9
 v_add_u32 v10, 0x10000, v10
 v_add_u32 v11, 0x10000, v11
 s_waitcnt vmcnt(5)
 v_mfma_f32_16x16x32_bf16 v[112:115], v[128:131], v[188:191], v[112:115]
 ds_read_b64_tr_b16 v[240:241], v8 offset:32768
 ds_read_b64_tr_b16 v[242:243], v8 offset:40960
 buffer_load_dwordx4 v[212:215], v2, s[44:47], s60 offen offset:2048 sc1
 v_mfma_f32_16x16x32_bf16 v[116:119], v[132:135], v[188:191], v[116:119]
 ds_read_b64_tr_b16 v[244:245], v9 offset:32768
 ds_read_b64_tr_b16 v[246:247], v9 offset:40960
 v_mfma_f32_16x16x32_bf16 v[120:123], v[136:139], v[188:191], v[120:123]
 ds_read_b64_tr_b16 v[248:249], v10 offset:32768
 ds_read_b64_tr_b16 v[250:251], v10 offset:40960
 v_mfma_f32_16x16x32_bf16 v[124:127], v[140:143], v[188:191], v[124:127]
 ds_read_b64_tr_b16 v[252:253], v11 offset:32768
 ds_read_b64_tr_b16 v[254:255], v11 offset:40960
 s_waitcnt vmcnt(5)
 s_waitcnt lgkmcnt(15)
 v_mfma_f32_16x16x32_bf16 v[112:115], v[144:147], v[192:195], v[112:115]
 ds_read_b64_tr_b16 v[16:17], v8 offset:36864
 ds_read_b64_tr_b16 v[18:19], v8 offset:45056
 s_add_u32 s60, s68, 24576
 buffer_load_dwordx4 v[216:219], v2, s[44:47], s60 offen offset:0 sc1
 v_mfma_f32_16x16x32_bf16 v[116:119], v[148:151], v[192:195], v[116:119]
 ds_read_b64_tr_b16 v[20:21], v9 offset:36864
 ds_read_b64_tr_b16 v[22:23], v9 offset:45056
 v_mfma_f32_16x16x32_bf16 v[120:123], v[152:155], v[192:195], v[120:123]
 ds_read_b64_tr_b16 v[24:25], v10 offset:36864
 ds_read_b64_tr_b16 v[26:27], v10 offset:45056
 v_mfma_f32_16x16x32_bf16 v[124:127], v[156:159], v[192:195], v[124:127]
 ds_read_b64_tr_b16 v[28:29], v11 offset:36864
 ds_read_b64_tr_b16 v[30:31], v11 offset:45056
 s_waitcnt vmcnt(5)
 s_waitcnt lgkmcnt(15)
 v_mfma_f32_16x16x32_bf16 v[112:115], v[224:227], v[196:199], v[112:115]
 ds_read_b64_tr_b16 v[32:33], v8 offset:49152
 ds_read_b64_tr_b16 v[34:35], v8 offset:57344
 buffer_load_dwordx4 v[220:223], v2, s[44:47], s60 offen offset:2048 sc1
 v_mfma_f32_16x16x32_bf16 v[116:119], v[228:231], v[196:199], v[116:119]
 ds_read_b64_tr_b16 v[36:37], v9 offset:49152
 ds_read_b64_tr_b16 v[38:39], v9 offset:57344
 v_mfma_f32_16x16x32_bf16 v[120:123], v[232:235], v[196:199], v[120:123]
 ds_read_b64_tr_b16 v[40:41], v10 offset:49152
 ds_read_b64_tr_b16 v[42:43], v10 offset:57344
 v_mfma_f32_16x16x32_bf16 v[124:127], v[236:239], v[196:199], v[124:127]
 ds_read_b64_tr_b16 v[44:45], v11 offset:49152
 ds_read_b64_tr_b16 v[46:47], v11 offset:57344
 s_waitcnt vmcnt(5)
 s_waitcnt lgkmcnt(15)
 v_mfma_f32_16x16x32_bf16 v[112:115], v[240:243], v[200:203], v[112:115]
 ds_read_b64_tr_b16 v[48:49], v8 offset:53248
 ds_read_b64_tr_b16 v[50:51], v8 offset:61440
 v_mfma_f32_16x16x32_bf16 v[116:119], v[244:247], v[200:203], v[116:119]
 ds_read_b64_tr_b16 v[52:53], v9 offset:53248
 ds_read_b64_tr_b16 v[54:55], v9 offset:61440
 v_mfma_f32_16x16x32_bf16 v[120:123], v[248:251], v[200:203], v[120:123]
 ds_read_b64_tr_b16 v[56:57], v10 offset:53248
 ds_read_b64_tr_b16 v[58:59], v10 offset:61440
 v_mfma_f32_16x16x32_bf16 v[124:127], v[252:255], v[200:203], v[124:127]
 ds_read_b64_tr_b16 v[60:61], v11 offset:53248
 ds_read_b64_tr_b16 v[62:63], v11 offset:61440
 s_waitcnt vmcnt(4)
 s_waitcnt lgkmcnt(15)
 v_mfma_f32_16x16x32_bf16 v[112:115], v[16:19], v[204:207], v[112:115]
 ds_read_b64_tr_b16 v[64:65], v8 offset:0
 ds_read_b64_tr_b16 v[66:67], v8 offset:8192
 v_mfma_f32_16x16x32_bf16 v[116:119], v[20:23], v[204:207], v[116:119]
 ds_read_b64_tr_b16 v[68:69], v9 offset:0
 ds_read_b64_tr_b16 v[70:71], v9 offset:8192
 v_mfma_f32_16x16x32_bf16 v[120:123], v[24:27], v[204:207], v[120:123]
 ds_read_b64_tr_b16 v[72:73], v10 offset:0
 ds_read_b64_tr_b16 v[74:75], v10 offset:8192
 v_mfma_f32_16x16x32_bf16 v[124:127], v[28:31], v[204:207], v[124:127]
 ds_read_b64_tr_b16 v[76:77], v11 offset:0
 ds_read_b64_tr_b16 v[78:79], v11 offset:8192
 s_waitcnt vmcnt(3)
 s_waitcnt lgkmcnt(15)
 v_mfma_f32_16x16x32_bf16 v[112:115], v[32:35], v[208:211], v[112:115]
 ds_read_b64_tr_b16 v[80:81], v8 offset:4096
 ds_read_b64_tr_b16 v[82:83], v8 offset:12288
 v_mfma_f32_16x16x32_bf16 v[116:119], v[36:39], v[208:211], v[116:119]
 ds_read_b64_tr_b16 v[84:85], v9 offset:4096
 ds_read_b64_tr_b16 v[86:87], v9 offset:12288
 v_mfma_f32_16x16x32_bf16 v[120:123], v[40:43], v[208:211], v[120:123]
 ds_read_b64_tr_b16 v[88:89], v10 offset:4096
 ds_read_b64_tr_b16 v[90:91], v10 offset:12288
 v_mfma_f32_16x16x32_bf16 v[124:127], v[44:47], v[208:211], v[124:127]
 ds_read_b64_tr_b16 v[92:93], v11 offset:4096
 ds_read_b64_tr_b16 v[94:95], v11 offset:12288
 s_waitcnt vmcnt(2)
 s_waitcnt lgkmcnt(15)
 v_mfma_f32_16x16x32_bf16 v[112:115], v[48:51], v[212:215], v[112:115]
 v_mfma_f32_16x16x32_bf16 v[116:119], v[52:55], v[212:215], v[116:119]
 v_mfma_f32_16x16x32_bf16 v[120:123], v[56:59], v[212:215], v[120:123]
 v_mfma_f32_16x16x32_bf16 v[124:127], v[60:63], v[212:215], v[124:127]
 s_waitcnt vmcnt(1)
 s_waitcnt lgkmcnt(14)
 v_mfma_f32_16x16x32_bf16 v[112:115], v[64:67], v[216:219], v[112:115]
 s_waitcnt lgkmcnt(12)
 v_mfma_f32_16x16x32_bf16 v[116:119], v[68:71], v[216:219], v[116:119]
 s_waitcnt lgkmcnt(10)
 v_mfma_f32_16x16x32_bf16 v[120:123], v[72:75], v[216:219], v[120:123]
 s_waitcnt lgkmcnt(8)
 v_mfma_f32_16x16x32_bf16 v[124:127], v[76:79], v[216:219], v[124:127]
 s_waitcnt vmcnt(0)
 s_waitcnt lgkmcnt(6)
 v_mfma_f32_16x16x32_bf16 v[112:115], v[80:83], v[220:223], v[112:115]
 s_waitcnt lgkmcnt(4)
 v_mfma_f32_16x16x32_bf16 v[116:119], v[84:87], v[220:223], v[116:119]
 s_waitcnt lgkmcnt(2)
 v_mfma_f32_16x16x32_bf16 v[120:123], v[88:91], v[220:223], v[120:123]
 s_waitcnt lgkmcnt(0)
 v_mfma_f32_16x16x32_bf16 v[124:127], v[92:95], v[220:223], v[124:127]
 s_nop 1
 ds_write_b128 v14, v[112:115]
 s_nop 0
 ds_write_b128 v3, v[116:119]
 s_nop 0
 ds_write_b128 v4, v[120:123]
 s_nop 0
 ds_write_b128 v5, v[124:127]
 s_waitcnt lgkmcnt(0)
 s_barrier
 ds_read_b128 v[112:115], v15 offset:0
 ds_read_b128 v[120:123], v15 offset:16384
 ds_read_b128 v[116:119], v7 offset:0
 ds_read_b128 v[124:127], v7 offset:16384
 s_mov_b32 s76, 0xbfb8aa3b
 s_mov_b32 s77, s76
 s_waitcnt lgkmcnt(2)
 v_pk_add_f32 v[112:113], v[112:113], v[120:121]
 v_pk_add_f32 v[114:115], v[114:115], v[122:123]
 v_pk_mul_f32 v[48:49], v[112:113], s[76:77]
 v_pk_mul_f32 v[50:51], v[114:115], s[76:77]
 v_exp_f32 v48, v48
 v_exp_f32 v49, v49
 v_exp_f32 v50, v50
 v_exp_f32 v51, v51
 s_waitcnt lgkmcnt(0)
 v_pk_add_f32 v[116:117], v[116:117], v[124:125]
 v_pk_add_f32 v[118:119], v[118:119], v[126:127]
 v_pk_mul_f32 v[52:53], v[116:117], s[76:77]
 v_pk_mul_f32 v[54:55], v[118:119], s[76:77]
 v_exp_f32 v52, v52
 v_exp_f32 v53, v53
 v_exp_f32 v54, v54
 v_exp_f32 v55, v55
 v_pk_add_f32 v[48:49], v[48:49], 1.0 op_sel_hi:[1,0]
 v_pk_add_f32 v[50:51], v[50:51], 1.0 op_sel_hi:[1,0]
 v_pk_add_f32 v[52:53], v[52:53], 1.0 op_sel_hi:[1,0]
 v_pk_add_f32 v[54:55], v[54:55], 1.0 op_sel_hi:[1,0]
 v_rcp_f32 v48, v48
 v_rcp_f32 v49, v49
 v_rcp_f32 v50, v50
 v_rcp_f32 v51, v51
 v_rcp_f32 v52, v52
 v_rcp_f32 v53, v53
 v_rcp_f32 v54, v54
 v_rcp_f32 v55, v55
 v_pk_mul_f32 v[96:97], v[96:97], v[112:113]
 v_pk_mul_f32 v[98:99], v[98:99], v[114:115]
 v_pk_mul_f32 v[100:101], v[100:101], v[116:117]
 v_pk_mul_f32 v[102:103], v[102:103], v[118:119]
 v_pk_fma_f32 v[104:105], v[48:49], v[96:97], v[104:105]
 v_pk_fma_f32 v[106:107], v[50:51], v[98:99], v[106:107]
 v_pk_fma_f32 v[108:109], v[52:53], v[100:101], v[108:109]
 v_pk_fma_f32 v[110:111], v[54:55], v[102:103], v[110:111]
 v_cvt_pk_bf16_f32 v112, v104, v105
 v_cvt_pk_bf16_f32 v113, v106, v107
 v_cvt_pk_bf16_f32 v114, v108, v109
 v_cvt_pk_bf16_f32 v115, v110, v111
 buffer_store_dwordx4 v[112:115], v160, s[36:39], s79 offen sc1
 s_endpgm
L_end:
.section .rodata,"a"
.p2align 6
.amdhsa_kernel recurrent_scan__sliding_local_dilated__mixer_gmlp__prompt_kernel
  .amdhsa_next_free_vgpr 256
  .amdhsa_next_free_sgpr 102
  .amdhsa_accum_offset 256
  .amdhsa_group_segment_fixed_size 0
  .amdhsa_kernarg_size 88
  .amdhsa_user_sgpr_count 2
  .amdhsa_user_sgpr_kernarg_segment_ptr 1
  .amdhsa_system_sgpr_workgroup_id_x 1
.end_amdhsa_kernel
```
